```python
import torch

def _softmax(x, axis=-1):
    return torch.softmax(x, dim=axis)
def _gelu(x):
    return torch.nn.functional.gelu(x, approximate="tanh")
def _silu(x):
    return torch.nn.functional.silu(x)
def _sigmoid(x):
    return torch.sigmoid(x)
def _layernorm(x, axis=-1, eps=1e-5):
    m = x.mean(dim=axis, keepdim=True)
    v = x.var(dim=axis, keepdim=True, unbiased=False)
    return (x - m) / torch.sqrt(v + eps)
def _scatter_add(tgt, idx, src, axis=0):
    return tgt.clone().index_add_(axis, idx, src)
def _segment_sum(src, seg, n):
    out = torch.zeros((n,) + src.shape[1:], dtype=src.dtype)
    return out.index_add_(0, seg, src)
def _pad(x, pw):
    flat = tuple(v for pair in reversed(pw) for v in pair)
    return torch.nn.functional.pad(x, flat)

kernel_name = 'recurrent_scan__softmax_full_mha__geglu_ffn__prompt'

def setup_inputs():

    _w = (lambda a: (lambda t: t.to(torch.bfloat16) if t.is_floating_point() else t)(torch.as_tensor(a)))
    def _A_setup():
        B, S, D = 1, 2048, 576
        return {
            "x": _w((lambda *s: torch.randn(*s, dtype=torch.bfloat16) * 0.05)(B, S, D)),
            "wqkv": _w((lambda *s: torch.randn(*s, dtype=torch.bfloat16) * 0.05)(D, 3 * D)),
            "wo": _w((lambda *s: torch.randn(*s, dtype=torch.bfloat16) * 0.05)(D, D)),
        }
    _A_in = _A_setup()

    def _B_setup():
        B, S, D, F = 1, 2048, 576, 4608
        return {
            "x": _w((lambda *s: torch.randn(*s, dtype=torch.bfloat16) * 0.05)(B, S, D)),
            "w_gate": _w((lambda *s: torch.randn(*s, dtype=torch.bfloat16) * 0.05)(D, F)),
            "w_up": _w((lambda *s: torch.randn(*s, dtype=torch.bfloat16) * 0.05)(D, F)),
            "w_down": _w((lambda *s: torch.randn(*s, dtype=torch.bfloat16) * 0.05)(F, D)),
        }
    _B_in = _B_setup()

    return {
        "A_x": _A_in["x"],
        "A_wqkv": _A_in["wqkv"],
        "A_wo": _A_in["wo"],
        "B_x": _B_in["x"],
        "B_w_gate": _B_in["w_gate"],
        "B_w_up": _B_in["w_up"],
        "B_w_down": _B_in["w_down"],
    }

def reference(A_x, A_wqkv, A_wo, B_x, B_w_gate, B_w_up, B_w_down):
    def _A_ref(x, wqkv, wo):
        B, S, D = x.shape
        H = 32; Dh = D // H
        qkv = (lambda x, *d: x.permute(*d))((x @ wqkv).reshape(B, S, 3, H, Dh), 2, 0, 3, 1, 4)
        q, k, v = qkv[0], qkv[1], qkv[2]
        scale = Dh ** -0.5
        scores = torch.einsum("bhqd,bhkd->bhqk", q, k) * scale
        p = _softmax(scores, axis=-1)
        o = torch.einsum("bhqk,bhkd->bhqd", p, v)
        return (lambda x, *d: x.permute(*d))(o, 0, 2, 1, 3).reshape(B, S, D) @ wo

    def _B_ref(x, w_gate, w_up, w_down):
        return (_gelu(x @ w_gate) * (x @ w_up)) @ w_down

    x = A_x
    xn = _layernorm(x, axis=-1)
    s = _A_ref(xn, A_wqkv, A_wo)
    g = _silu(_B_ref(xn, B_w_gate, B_w_up, B_w_down))
    return x + s * g
```

```asm
; @launch grid=(256,1,1) block=(512,1,1) lds=163840
.amdgcn_target "amdgcn-amd-amdhsa--gfx950"
.text
.globl recurrent_scan__softmax_full_mha__geglu_ffn__prompt_kernel
.p2align 8
.type recurrent_scan__softmax_full_mha__geglu_ffn__prompt_kernel,@function
recurrent_scan__softmax_full_mha__geglu_ffn__prompt_kernel:
    s_cmp_ge_u32 s2, 256
    s_cbranch_scc1 K1_END
    s_load_dwordx4 s[48:51], s[0:1], 0
    s_load_dwordx4 s[52:55], s[0:1], 32
    s_load_dwordx2 s[56:57], s[0:1], 48
    s_load_dwordx2 s[58:59], s[0:1], 72
    s_load_dwordx2 s[94:95], s[0:1], 16
    s_load_dwordx4 s[96:99], s[0:1], 56
    v_lshrrev_b32 v220, 6, v0
    v_and_b32 v0, 63, v0
    v_readfirstlane_b32 s28, v220
    s_nop 1
    s_lshr_b32 s29, s28, 2
    s_and_b32 s30, s28, 3
    s_and_b32 s41, s2, 3
    s_lshl_b32 s31, s41, 2
    s_bfe_u32 s41, s2, 0x20003
    s_add_u32 s31, s31, s41
    s_bfe_u32 s32, s2, 0x10002
    s_lshr_b32 s41, s2, 5
    s_lshl_b32 s41, s41, 1
    s_add_u32 s32, s32, s41
    v_lshrrev_b32 v220, 3, v0
    v_mul_u32_u24 v154, 1152, v220
    v_and_b32 v221, 7, v0
    v_lshl_add_u32 v154, v221, 4, v154
    s_lshl_b32 s41, s31, 3
    s_add_u32 s41, s41, s28
    s_mul_i32 s41, s41, 18432
    s_add_u32 s42, s41, 9216
    s_waitcnt lgkmcnt(0)
    s_mov_b32 s8, s48
    s_mov_b32 s9, s49
    s_mov_b32 s10, 2359296
    s_mov_b32 s11, 0x20000
    buffer_load_dwordx4 v[76:79], v154, s[8:11], s41 offen offset:0
    buffer_load_dwordx4 v[84:87], v154, s[8:11], s41 offen offset:128
    buffer_load_dwordx4 v[92:95], v154, s[8:11], s41 offen offset:256
    buffer_load_dwordx4 v[100:103], v154, s[8:11], s41 offen offset:384
    buffer_load_dwordx4 v[108:111], v154, s[8:11], s41 offen offset:512
    buffer_load_dwordx4 v[116:119], v154, s[8:11], s41 offen offset:640
    buffer_load_dwordx4 v[124:127], v154, s[8:11], s41 offen offset:768
    buffer_load_dwordx4 v[132:135], v154, s[8:11], s41 offen offset:896
    buffer_load_dwordx4 v[140:143], v154, s[8:11], s41 offen offset:1024
    s_mov_b32 s38, s42
    s_lshl_b32 s41, s28, 3
    v_add_u32 v241, s41, v220
    v_bfe_u32 v222, v0, 4, 1
    v_lshlrev_b32 v222, 2, v222
    v_xor_b32 v222, v222, v221
    s_and_b32 s41, s28, 1
    s_lshl_b32 s41, s41, 1
    v_xor_b32 v222, s41, v222
    v_lshlrev_b32 v242, 4, v222
    v_mul_u32_u24 v240, 3456, v241
    v_add_u32 v240, v240, v242
    v_mul_u32_u24 v239, 9216, v241
    v_add_u32 v239, v239, v242
    s_lshl_b32 s33, s28, 10
    s_lshl_b32 s35, s32, 7
    s_mov_b32 s37, 221184
    s_mov_b32 s36, 589824
    s_mul_i32 s40, s32, 5
    s_lshl_b32 s41, s32, 2
    s_add_u32 s41, s41, 8
    s_cmp_lt_u32 s32, 8
    s_cselect_b32 s40, s40, s41
    s_cselect_b32 s46, 5, 4
    s_lshl_b32 s43, s40, 11
    s_lshl_b32 s40, s40, 7
    s_mov_b32 s34, s40
    s_mov_b32 s16, s50
    s_mov_b32 s17, s51
    s_mov_b32 s18, 1990656
    s_mov_b32 s19, 0x20000
    s_mov_b32 s20, s58
    s_mov_b32 s21, s59
    s_mov_b32 s22, 67108864
    s_mov_b32 s23, 0x20000
    s_mov_b32 s24, s58
    s_mov_b32 s25, s59
    s_mov_b32 s26, 0
    s_mov_b32 s27, 0x20000
    s_sub_u32 s93, s32, 8
    s_mov_b32 s60, 5308416
    s_mov_b32 s88, 5308416
    s_mov_b32 s61, s40
    s_mov_b32 s89, s40
    s_mov_b32 s86, s52
    s_mov_b32 s87, s53
    s_mov_b32 s90, 9216
    s_mov_b32 s100, s54
    s_mov_b32 s101, s55
    s_mov_b32 s3, 9216
    s_mov_b32 s91, 0
    s_mov_b32 s92, 0
    s_mov_b32 s63, 0
    s_mov_b32 s84, 0
    s_cmp_lt_u32 s32, 8
    s_cbranch_scc1 K1_BD
    s_mov_b32 s86, s50
    s_mov_b32 s87, s51
    s_mov_b32 s90, 3456
    s_mov_b32 s100, s50
    s_mov_b32 s101, s51
    s_mov_b32 s3, 3456
    s_mov_b32 s60, 1990656
    s_add_u32 s61, s93, 16
    s_lshl_b32 s61, s61, 7
    s_mov_b32 s88, 1990656
    s_add_u32 s89, s61, 1024
    s_add_u32 s63, s93, 6
    s_mov_b32 s91, 1
    s_cmp_lt_u32 s93, 3
    s_cbranch_scc1 K1_BD
    s_mov_b32 s89, s61
    s_sub_u32 s63, s93, 2
    s_mul_i32 s41, s31, 5
    s_add_u32 s41, s41, s93
    s_sub_u32 s41, s41, 3
    s_mov_b32 s84, s41
    s_mov_b32 s91, 2
    s_mov_b32 s86, s56
    s_mov_b32 s87, s57
    s_mov_b32 s60, 5308416
    s_mov_b32 s90, 1152
    s_cmp_ge_u32 s41, 0
    s_cselect_b32 s91, 3, s91
    s_cselect_b32 s60, 0, s60
    s_mul_i32 s42, s41, 57
    s_lshr_b32 s42, s42, 9
    s_mul_i32 s61, s42, 9
    s_sub_u32 s41, s41, s61
    s_mul_i32 s61, s42, 663552
    s_mul_i32 s92, s42, 663552
    s_lshl_b32 s42, s41, 7
    s_add_u32 s61, s61, s42
    s_lshl_b32 s42, s41, 12
    s_add_u32 s92, s92, s42
K1_BD:
    s_mov_b32 s12, s86
    s_mov_b32 s13, s87
    s_mov_b32 s14, s60
    s_mov_b32 s15, 0x20000
    s_mov_b32 s34, s61
    s_lshl_b32 s36, s90, 6
    v_mul_u32_u24 v239, s90, v241
    v_add_u32 v239, v239, v242
    v_lshrrev_b32 v220, 5, v0
    v_bfe_u32 v221, v0, 2, 2
    v_bfe_u32 v222, v0, 3, 1
    v_xor_b32 v222, s29, v222
    v_lshlrev_b32 v222, 6, v222
    v_lshl_add_u32 v222, v221, 7, v222
    v_bfe_u32 v223, v0, 4, 1
    v_and_b32 v224, 3, v0
    v_lshrrev_b32 v225, 4, v0
    v_lshl_add_u32 v236, v225, 10, v222
    v_lshl_add_u32 v236, v223, 5, v236
    v_lshl_add_u32 v236, v224, 3, v236
    v_xor_b32 v237, 32, v236
    v_lshl_add_u32 v238, v225, 9, v222
    v_bfe_u32 v226, v0, 1, 1
    v_xor_b32 v226, v226, v220
    v_lshl_add_u32 v238, v226, 5, v238
    v_and_b32 v226, 1, v0
    v_lshl_add_u32 v238, v226, 4, v238
    s_and_b32 s41, s30, 1
    s_lshl_b32 s41, s41, 3
    s_lshr_b32 s42, s30, 1
    s_lshl_b32 s42, s42, 12
    s_add_u32 s41, s41, s42
    v_add_u32 v238, s41, v238
    v_and_b32 v221, 15, v0
    s_lshl_b32 s41, s30, 12
    s_add_u32 s41, s41, 98304
    v_lshlrev_b32 v222, 7, v221
    v_add_u32 v222, s41, v222
    v_bfe_u32 v223, v0, 1, 3
    v_xor_b32 v223, v223, v225
    v_lshl_add_u32 v148, v223, 4, v222
    v_add_u32 v149, 2048, v148
    v_xor_b32 v150, 64, v148
    v_xor_b32 v151, 64, v149
    v_lshlrev_b32 v246, 14, v225
    v_lshl_add_u32 v246, v221, 3, v246
    v_lshrrev_b32 v222, 3, v0
    s_lshl_b32 s41, s28, 11
    s_add_u32 s41, s41, 98304
    v_lshlrev_b32 v222, 7, v222
    v_add_u32 v222, s41, v222
    v_lshrrev_b32 v223, 4, v0
    v_xor_b32 v223, v223, v0
    v_and_b32 v223, 7, v223
    v_lshl_add_u32 v152, v223, 4, v222
    v_xor_b32 v153, 64, v152
    v_add_u32 v153, 1024, v153
    v_lshlrev_b32 v243, 4, v0
    v_and_b32 v222, 15, v0
    v_lshlrev_b32 v222, 4, v222
    v_lshl_add_u32 v222, v220, 8, v222
    v_bfe_u32 v223, v0, 4, 1
    v_lshl_add_u32 v245, v223, 10, v222
    v_add_u32 v244, 147456, v243
    v_mov_b32 v160, 0x3f803f80
    v_mov_b32 v248, 0xffff0000
    v_mov_b32 v247, 0xbdd2d3e8
    v_mov_b32 v156, 0
    v_mov_b32 v157, 0
    v_mov_b32 v158, 0
    v_mov_b32 v159, 0
    s_lshl_b32 s47, s31, 2
    s_add_u32 s47, s47, s30
    s_mul_i32 s41, s47, 294912
    s_add_u32 s43, s43, s41
    s_lshl_b32 s41, s29, 10
    s_add_u32 s43, s43, s41
    s_add_u32 s43, s43, 8386560
    s_lshl_b32 s44, s32, 18
    s_lshl_b32 s42, s29, 17
    s_add_u32 s44, s44, s42
    s_lshl_b32 s42, s47, 8
    s_add_u32 s44, s44, s42
    s_mov_b32 s45, 1.0
    s_cmp_lt_u32 s32, 9
    s_cselect_b32 s45, 0x3eae1a93, s45
    s_cmp_lg_u32 s29, 0
    s_cselect_b64 vcc, -1, 0
    s_lshl_b32 s41, s2, 3
    s_add_u32 s41, s41, s28
    s_cmp_ge_u32 s41, 36
    s_cbranch_scc1 K1_NZ
    s_lshl_b32 s41, s41, 10
    s_add_u32 s41, s41, 54525952
    buffer_store_dwordx4 v[156:159], v243, s[20:23], s41 offen sc1
    s_nop 1
K1_NZ:
    buffer_load_dwordx4 v[80:83], v154, s[8:11], s38 offen offset:0
    buffer_load_dwordx4 v[88:91], v154, s[8:11], s38 offen offset:128
    buffer_load_dwordx4 v[96:99], v154, s[8:11], s38 offen offset:256
    buffer_load_dwordx4 v[104:107], v154, s[8:11], s38 offen offset:384
    buffer_load_dwordx4 v[112:115], v154, s[8:11], s38 offen offset:512
    buffer_load_dwordx4 v[120:123], v154, s[8:11], s38 offen offset:640
    buffer_load_dwordx4 v[128:131], v154, s[8:11], s38 offen offset:768
    buffer_load_dwordx4 v[136:139], v154, s[8:11], s38 offen offset:896
    buffer_load_dwordx4 v[144:147], v154, s[8:11], s38 offen offset:1024
    s_waitcnt vmcnt(17)
    v_dot2c_f32_bf16 v156, v76, v160
    v_dot2c_f32_bf16 v157, v76, v76
    v_dot2c_f32_bf16 v156, v77, v160
    v_dot2c_f32_bf16 v157, v77, v77
    v_dot2c_f32_bf16 v156, v78, v160
    v_dot2c_f32_bf16 v157, v78, v78
    v_dot2c_f32_bf16 v156, v79, v160
    v_dot2c_f32_bf16 v157, v79, v79
    s_waitcnt vmcnt(16)
    v_dot2c_f32_bf16 v156, v84, v160
    v_dot2c_f32_bf16 v157, v84, v84
    v_dot2c_f32_bf16 v156, v85, v160
    v_dot2c_f32_bf16 v157, v85, v85
    v_dot2c_f32_bf16 v156, v86, v160
    v_dot2c_f32_bf16 v157, v86, v86
    v_dot2c_f32_bf16 v156, v87, v160
    v_dot2c_f32_bf16 v157, v87, v87
    s_waitcnt vmcnt(15)
    v_dot2c_f32_bf16 v156, v92, v160
    v_dot2c_f32_bf16 v157, v92, v92
    v_dot2c_f32_bf16 v156, v93, v160
    v_dot2c_f32_bf16 v157, v93, v93
    v_dot2c_f32_bf16 v156, v94, v160
    v_dot2c_f32_bf16 v157, v94, v94
    v_dot2c_f32_bf16 v156, v95, v160
    v_dot2c_f32_bf16 v157, v95, v95
    s_waitcnt vmcnt(14)
    v_dot2c_f32_bf16 v156, v100, v160
    v_dot2c_f32_bf16 v157, v100, v100
    v_dot2c_f32_bf16 v156, v101, v160
    v_dot2c_f32_bf16 v157, v101, v101
    v_dot2c_f32_bf16 v156, v102, v160
    v_dot2c_f32_bf16 v157, v102, v102
    v_dot2c_f32_bf16 v156, v103, v160
    v_dot2c_f32_bf16 v157, v103, v103
    s_waitcnt vmcnt(13)
    v_dot2c_f32_bf16 v156, v108, v160
    v_dot2c_f32_bf16 v157, v108, v108
    v_dot2c_f32_bf16 v156, v109, v160
    v_dot2c_f32_bf16 v157, v109, v109
    v_dot2c_f32_bf16 v156, v110, v160
    v_dot2c_f32_bf16 v157, v110, v110
    v_dot2c_f32_bf16 v156, v111, v160
    v_dot2c_f32_bf16 v157, v111, v111
    s_waitcnt vmcnt(12)
    v_dot2c_f32_bf16 v156, v116, v160
    v_dot2c_f32_bf16 v157, v116, v116
    v_dot2c_f32_bf16 v156, v117, v160
    v_dot2c_f32_bf16 v157, v117, v117
    v_dot2c_f32_bf16 v156, v118, v160
    v_dot2c_f32_bf16 v157, v118, v118
    v_dot2c_f32_bf16 v156, v119, v160
    v_dot2c_f32_bf16 v157, v119, v119
    s_waitcnt vmcnt(11)
    v_dot2c_f32_bf16 v156, v124, v160
    v_dot2c_f32_bf16 v157, v124, v124
    v_dot2c_f32_bf16 v156, v125, v160
    v_dot2c_f32_bf16 v157, v125, v125
    v_dot2c_f32_bf16 v156, v126, v160
    v_dot2c_f32_bf16 v157, v126, v126
    v_dot2c_f32_bf16 v156, v127, v160
    v_dot2c_f32_bf16 v157, v127, v127
    s_waitcnt vmcnt(10)
    v_dot2c_f32_bf16 v156, v132, v160
    v_dot2c_f32_bf16 v157, v132, v132
    v_dot2c_f32_bf16 v156, v133, v160
    v_dot2c_f32_bf16 v157, v133, v133
    v_dot2c_f32_bf16 v156, v134, v160
    v_dot2c_f32_bf16 v157, v134, v134
    v_dot2c_f32_bf16 v156, v135, v160
    v_dot2c_f32_bf16 v157, v135, v135
    s_waitcnt vmcnt(9)
    v_dot2c_f32_bf16 v156, v140, v160
    v_dot2c_f32_bf16 v157, v140, v140
    v_dot2c_f32_bf16 v156, v141, v160
    v_dot2c_f32_bf16 v157, v141, v141
    v_dot2c_f32_bf16 v156, v142, v160
    v_dot2c_f32_bf16 v157, v142, v142
    v_dot2c_f32_bf16 v156, v143, v160
    v_dot2c_f32_bf16 v157, v143, v143
    s_nop 1
    v_add_f32_dpp v156, v156, v156 quad_perm:[1,0,3,2] row_mask:0xf bank_mask:0xf
    v_add_f32_dpp v157, v157, v157 quad_perm:[1,0,3,2] row_mask:0xf bank_mask:0xf
    s_nop 0
    v_add_f32_dpp v156, v156, v156 quad_perm:[2,3,0,1] row_mask:0xf bank_mask:0xf
    v_add_f32_dpp v157, v157, v157 quad_perm:[2,3,0,1] row_mask:0xf bank_mask:0xf
    s_nop 0
    v_add_f32_dpp v156, v156, v156 row_half_mirror row_mask:0xf bank_mask:0xf
    v_add_f32_dpp v157, v157, v157 row_half_mirror row_mask:0xf bank_mask:0xf
    v_mul_f32 v156, 0x3ae38e39, v156
    v_mul_f32 v157, 0x3ae38e39, v157
    v_fma_f32 v157, -v156, v156, v157
    v_max_f32 v157, 0, v157
    v_cvt_pk_bf16_f32 v220, v156, v157
    v_lshlrev_b32 v157, 16, v220
    v_and_b32 v220, v248, v220
    v_add_f32 v220, 0x3727c5ac, v220
    v_cvt_pk_bf16_f32 v220, v220, v220
    v_and_b32 v220, v248, v220
    v_sqrt_f32 v220, v220
    s_nop 0
    v_cvt_pk_bf16_f32 v220, v220, v220
    v_and_b32 v220, v248, v220
    v_rcp_f32 v156, v220
    s_nop 0
    v_mul_f32_e64 v157, -v157, v156
    v_lshlrev_b32 v180, 16, v76
    v_and_b32 v181, v248, v76
    v_lshlrev_b32 v182, 16, v77
    v_and_b32 v183, v248, v77
    v_lshlrev_b32 v184, 16, v78
    v_and_b32 v185, v248, v78
    v_lshlrev_b32 v186, 16, v79
    v_and_b32 v187, v248, v79
    v_pk_fma_f32 v[180:181], v[180:181], v[156:157], v[156:157] op_sel:[0,0,1] op_sel_hi:[1,0,1]
    v_pk_fma_f32 v[182:183], v[182:183], v[156:157], v[156:157] op_sel:[0,0,1] op_sel_hi:[1,0,1]
    v_pk_fma_f32 v[184:185], v[184:185], v[156:157], v[156:157] op_sel:[0,0,1] op_sel_hi:[1,0,1]
    v_pk_fma_f32 v[186:187], v[186:187], v[156:157], v[156:157] op_sel:[0,0,1] op_sel_hi:[1,0,1]
    v_cvt_pk_bf16_f32 v76, v180, v181
    v_cvt_pk_bf16_f32 v77, v182, v183
    v_cvt_pk_bf16_f32 v78, v184, v185
    v_cvt_pk_bf16_f32 v79, v186, v187
    ds_write_b128 v152, v[76:79] offset:0
    v_lshlrev_b32 v180, 16, v84
    v_and_b32 v181, v248, v84
    v_lshlrev_b32 v182, 16, v85
    v_and_b32 v183, v248, v85
    v_lshlrev_b32 v184, 16, v86
    v_and_b32 v185, v248, v86
    v_lshlrev_b32 v186, 16, v87
    v_and_b32 v187, v248, v87
    v_pk_fma_f32 v[180:181], v[180:181], v[156:157], v[156:157] op_sel:[0,0,1] op_sel_hi:[1,0,1]
    v_pk_fma_f32 v[182:183], v[182:183], v[156:157], v[156:157] op_sel:[0,0,1] op_sel_hi:[1,0,1]
    v_pk_fma_f32 v[184:185], v[184:185], v[156:157], v[156:157] op_sel:[0,0,1] op_sel_hi:[1,0,1]
    v_pk_fma_f32 v[186:187], v[186:187], v[156:157], v[156:157] op_sel:[0,0,1] op_sel_hi:[1,0,1]
    v_cvt_pk_bf16_f32 v84, v180, v181
    v_cvt_pk_bf16_f32 v85, v182, v183
    v_cvt_pk_bf16_f32 v86, v184, v185
    v_cvt_pk_bf16_f32 v87, v186, v187
    ds_write_b128 v152, v[84:87] offset:16384
    v_lshlrev_b32 v180, 16, v92
    v_and_b32 v181, v248, v92
    v_lshlrev_b32 v182, 16, v93
    v_and_b32 v183, v248, v93
    v_lshlrev_b32 v184, 16, v94
    v_and_b32 v185, v248, v94
    v_lshlrev_b32 v186, 16, v95
    v_and_b32 v187, v248, v95
    v_pk_fma_f32 v[180:181], v[180:181], v[156:157], v[156:157] op_sel:[0,0,1] op_sel_hi:[1,0,1]
    v_pk_fma_f32 v[182:183], v[182:183], v[156:157], v[156:157] op_sel:[0,0,1] op_sel_hi:[1,0,1]
    v_pk_fma_f32 v[184:185], v[184:185], v[156:157], v[156:157] op_sel:[0,0,1] op_sel_hi:[1,0,1]
    v_pk_fma_f32 v[186:187], v[186:187], v[156:157], v[156:157] op_sel:[0,0,1] op_sel_hi:[1,0,1]
    v_cvt_pk_bf16_f32 v92, v180, v181
    v_cvt_pk_bf16_f32 v93, v182, v183
    v_cvt_pk_bf16_f32 v94, v184, v185
    v_cvt_pk_bf16_f32 v95, v186, v187
    ds_write_b128 v152, v[92:95] offset:32768
    v_lshlrev_b32 v180, 16, v100
    v_and_b32 v181, v248, v100
    v_lshlrev_b32 v182, 16, v101
    v_and_b32 v183, v248, v101
    v_lshlrev_b32 v184, 16, v102
    v_and_b32 v185, v248, v102
    v_lshlrev_b32 v186, 16, v103
    v_and_b32 v187, v248, v103
    v_pk_fma_f32 v[180:181], v[180:181], v[156:157], v[156:157] op_sel:[0,0,1] op_sel_hi:[1,0,1]
    v_pk_fma_f32 v[182:183], v[182:183], v[156:157], v[156:157] op_sel:[0,0,1] op_sel_hi:[1,0,1]
    v_pk_fma_f32 v[184:185], v[184:185], v[156:157], v[156:157] op_sel:[0,0,1] op_sel_hi:[1,0,1]
    v_pk_fma_f32 v[186:187], v[186:187], v[156:157], v[156:157] op_sel:[0,0,1] op_sel_hi:[1,0,1]
    v_cvt_pk_bf16_f32 v100, v180, v181
    v_cvt_pk_bf16_f32 v101, v182, v183
    v_cvt_pk_bf16_f32 v102, v184, v185
    v_cvt_pk_bf16_f32 v103, v186, v187
    ds_write_b128 v152, v[100:103] offset:49152
    v_lshlrev_b32 v180, 16, v108
    v_and_b32 v181, v248, v108
    v_lshlrev_b32 v182, 16, v109
    v_and_b32 v183, v248, v109
    v_lshlrev_b32 v184, 16, v110
    v_and_b32 v185, v248, v110
    v_lshlrev_b32 v186, 16, v111
    v_and_b32 v187, v248, v111
    v_pk_fma_f32 v[180:181], v[180:181], v[156:157], v[156:157] op_sel:[0,0,1] op_sel_hi:[1,0,1]
    v_pk_fma_f32 v[182:183], v[182:183], v[156:157], v[156:157] op_sel:[0,0,1] op_sel_hi:[1,0,1]
    v_pk_fma_f32 v[184:185], v[184:185], v[156:157], v[156:157] op_sel:[0,0,1] op_sel_hi:[1,0,1]
    v_pk_fma_f32 v[186:187], v[186:187], v[156:157], v[156:157] op_sel:[0,0,1] op_sel_hi:[1,0,1]
    v_cvt_pk_bf16_f32 v108, v180, v181
    v_cvt_pk_bf16_f32 v109, v182, v183
    v_cvt_pk_bf16_f32 v110, v184, v185
    v_cvt_pk_bf16_f32 v111, v186, v187
    v_lshlrev_b32 v180, 16, v116
    v_and_b32 v181, v248, v116
    v_lshlrev_b32 v182, 16, v117
    v_and_b32 v183, v248, v117
    v_lshlrev_b32 v184, 16, v118
    v_and_b32 v185, v248, v118
    v_lshlrev_b32 v186, 16, v119
    v_and_b32 v187, v248, v119
    v_pk_fma_f32 v[180:181], v[180:181], v[156:157], v[156:157] op_sel:[0,0,1] op_sel_hi:[1,0,1]
    v_pk_fma_f32 v[182:183], v[182:183], v[156:157], v[156:157] op_sel:[0,0,1] op_sel_hi:[1,0,1]
    v_pk_fma_f32 v[184:185], v[184:185], v[156:157], v[156:157] op_sel:[0,0,1] op_sel_hi:[1,0,1]
    v_pk_fma_f32 v[186:187], v[186:187], v[156:157], v[156:157] op_sel:[0,0,1] op_sel_hi:[1,0,1]
    v_cvt_pk_bf16_f32 v116, v180, v181
    v_cvt_pk_bf16_f32 v117, v182, v183
    v_cvt_pk_bf16_f32 v118, v184, v185
    v_cvt_pk_bf16_f32 v119, v186, v187
    v_lshlrev_b32 v180, 16, v124
    v_and_b32 v181, v248, v124
    v_lshlrev_b32 v182, 16, v125
    v_and_b32 v183, v248, v125
    v_lshlrev_b32 v184, 16, v126
    v_and_b32 v185, v248, v126
    v_lshlrev_b32 v186, 16, v127
    v_and_b32 v187, v248, v127
    v_pk_fma_f32 v[180:181], v[180:181], v[156:157], v[156:157] op_sel:[0,0,1] op_sel_hi:[1,0,1]
    v_pk_fma_f32 v[182:183], v[182:183], v[156:157], v[156:157] op_sel:[0,0,1] op_sel_hi:[1,0,1]
    v_pk_fma_f32 v[184:185], v[184:185], v[156:157], v[156:157] op_sel:[0,0,1] op_sel_hi:[1,0,1]
    v_pk_fma_f32 v[186:187], v[186:187], v[156:157], v[156:157] op_sel:[0,0,1] op_sel_hi:[1,0,1]
    v_cvt_pk_bf16_f32 v124, v180, v181
    v_cvt_pk_bf16_f32 v125, v182, v183
    v_cvt_pk_bf16_f32 v126, v184, v185
    v_cvt_pk_bf16_f32 v127, v186, v187
    v_lshlrev_b32 v180, 16, v132
    v_and_b32 v181, v248, v132
    v_lshlrev_b32 v182, 16, v133
    v_and_b32 v183, v248, v133
    v_lshlrev_b32 v184, 16, v134
    v_and_b32 v185, v248, v134
    v_lshlrev_b32 v186, 16, v135
    v_and_b32 v187, v248, v135
    v_pk_fma_f32 v[180:181], v[180:181], v[156:157], v[156:157] op_sel:[0,0,1] op_sel_hi:[1,0,1]
    v_pk_fma_f32 v[182:183], v[182:183], v[156:157], v[156:157] op_sel:[0,0,1] op_sel_hi:[1,0,1]
    v_pk_fma_f32 v[184:185], v[184:185], v[156:157], v[156:157] op_sel:[0,0,1] op_sel_hi:[1,0,1]
    v_pk_fma_f32 v[186:187], v[186:187], v[156:157], v[156:157] op_sel:[0,0,1] op_sel_hi:[1,0,1]
    v_cvt_pk_bf16_f32 v132, v180, v181
    v_cvt_pk_bf16_f32 v133, v182, v183
    v_cvt_pk_bf16_f32 v134, v184, v185
    v_cvt_pk_bf16_f32 v135, v186, v187
    v_lshlrev_b32 v180, 16, v140
    v_and_b32 v181, v248, v140
    v_lshlrev_b32 v182, 16, v141
    v_and_b32 v183, v248, v141
    v_lshlrev_b32 v184, 16, v142
    v_and_b32 v185, v248, v142
    v_lshlrev_b32 v186, 16, v143
    v_and_b32 v187, v248, v143
    v_pk_fma_f32 v[180:181], v[180:181], v[156:157], v[156:157] op_sel:[0,0,1] op_sel_hi:[1,0,1]
    v_pk_fma_f32 v[182:183], v[182:183], v[156:157], v[156:157] op_sel:[0,0,1] op_sel_hi:[1,0,1]
    v_pk_fma_f32 v[184:185], v[184:185], v[156:157], v[156:157] op_sel:[0,0,1] op_sel_hi:[1,0,1]
    v_pk_fma_f32 v[186:187], v[186:187], v[156:157], v[156:157] op_sel:[0,0,1] op_sel_hi:[1,0,1]
    v_cvt_pk_bf16_f32 v140, v180, v181
    v_cvt_pk_bf16_f32 v141, v182, v183
    v_cvt_pk_bf16_f32 v142, v184, v185
    v_cvt_pk_bf16_f32 v143, v186, v187
    s_add_u32 m0, s33, 0
    s_nop 0
    buffer_load_dwordx4 v240, s[16:19], s35 offen  lds
    s_add_u32 s35, s35, s37
    s_waitcnt vmcnt(9)
    v_dot2c_f32_bf16 v158, v80, v160
    v_dot2c_f32_bf16 v159, v80, v80
    v_dot2c_f32_bf16 v158, v81, v160
    v_dot2c_f32_bf16 v159, v81, v81
    v_dot2c_f32_bf16 v158, v82, v160
    v_dot2c_f32_bf16 v159, v82, v82
    v_dot2c_f32_bf16 v158, v83, v160
    v_dot2c_f32_bf16 v159, v83, v83
    s_waitcnt vmcnt(8)
    v_dot2c_f32_bf16 v158, v88, v160
    v_dot2c_f32_bf16 v159, v88, v88
    v_dot2c_f32_bf16 v158, v89, v160
    v_dot2c_f32_bf16 v159, v89, v89
    v_dot2c_f32_bf16 v158, v90, v160
    v_dot2c_f32_bf16 v159, v90, v90
    v_dot2c_f32_bf16 v158, v91, v160
    v_dot2c_f32_bf16 v159, v91, v91
    s_add_u32 m0, s33, 8192
    s_nop 0
    buffer_load_dwordx4 v240, s[16:19], s35 offen  lds
    s_add_u32 s35, s35, s37
    s_waitcnt vmcnt(8)
    v_dot2c_f32_bf16 v158, v96, v160
    v_dot2c_f32_bf16 v159, v96, v96
    v_dot2c_f32_bf16 v158, v97, v160
    v_dot2c_f32_bf16 v159, v97, v97
    v_dot2c_f32_bf16 v158, v98, v160
    v_dot2c_f32_bf16 v159, v98, v98
    v_dot2c_f32_bf16 v158, v99, v160
    v_dot2c_f32_bf16 v159, v99, v99
    s_waitcnt vmcnt(7)
    v_dot2c_f32_bf16 v158, v104, v160
    v_dot2c_f32_bf16 v159, v104, v104
    v_dot2c_f32_bf16 v158, v105, v160
    v_dot2c_f32_bf16 v159, v105, v105
    v_dot2c_f32_bf16 v158, v106, v160
    v_dot2c_f32_bf16 v159, v106, v106
    v_dot2c_f32_bf16 v158, v107, v160
    v_dot2c_f32_bf16 v159, v107, v107
    s_add_u32 m0, s33, 16384
    s_nop 0
    buffer_load_dwordx4 v240, s[16:19], s35 offen  lds
    s_add_u32 s35, s35, s37
    s_waitcnt vmcnt(7)
    v_dot2c_f32_bf16 v158, v112, v160
    v_dot2c_f32_bf16 v159, v112, v112
    v_dot2c_f32_bf16 v158, v113, v160
    v_dot2c_f32_bf16 v159, v113, v113
    v_dot2c_f32_bf16 v158, v114, v160
    v_dot2c_f32_bf16 v159, v114, v114
    v_dot2c_f32_bf16 v158, v115, v160
    v_dot2c_f32_bf16 v159, v115, v115
    s_waitcnt vmcnt(6)
    v_dot2c_f32_bf16 v158, v120, v160
    v_dot2c_f32_bf16 v159, v120, v120
    v_dot2c_f32_bf16 v158, v121, v160
    v_dot2c_f32_bf16 v159, v121, v121
    v_dot2c_f32_bf16 v158, v122, v160
    v_dot2c_f32_bf16 v159, v122, v122
    v_dot2c_f32_bf16 v158, v123, v160
    v_dot2c_f32_bf16 v159, v123, v123
    s_add_u32 m0, s33, 24576
    s_nop 0
    buffer_load_dwordx4 v240, s[16:19], s35 offen  lds
    s_add_u32 s35, s35, s37
    s_waitcnt vmcnt(6)
    v_dot2c_f32_bf16 v158, v128, v160
    v_dot2c_f32_bf16 v159, v128, v128
    v_dot2c_f32_bf16 v158, v129, v160
    v_dot2c_f32_bf16 v159, v129, v129
    v_dot2c_f32_bf16 v158, v130, v160
    v_dot2c_f32_bf16 v159, v130, v130
    v_dot2c_f32_bf16 v158, v131, v160
    v_dot2c_f32_bf16 v159, v131, v131
    s_waitcnt vmcnt(5)
    v_dot2c_f32_bf16 v158, v136, v160
    v_dot2c_f32_bf16 v159, v136, v136
    v_dot2c_f32_bf16 v158, v137, v160
    v_dot2c_f32_bf16 v159, v137, v137
    v_dot2c_f32_bf16 v158, v138, v160
    v_dot2c_f32_bf16 v159, v138, v138
    v_dot2c_f32_bf16 v158, v139, v160
    v_dot2c_f32_bf16 v159, v139, v139
    s_add_u32 m0, s33, 32768
    s_nop 0
    buffer_load_dwordx4 v240, s[16:19], s35 offen  lds
    s_add_u32 s35, s35, s37
    s_waitcnt vmcnt(5)
    v_dot2c_f32_bf16 v158, v144, v160
    v_dot2c_f32_bf16 v159, v144, v144
    v_dot2c_f32_bf16 v158, v145, v160
    v_dot2c_f32_bf16 v159, v145, v145
    v_dot2c_f32_bf16 v158, v146, v160
    v_dot2c_f32_bf16 v159, v146, v146
    v_dot2c_f32_bf16 v158, v147, v160
    v_dot2c_f32_bf16 v159, v147, v147
    s_nop 1
    v_add_f32_dpp v158, v158, v158 quad_perm:[1,0,3,2] row_mask:0xf bank_mask:0xf
    v_add_f32_dpp v159, v159, v159 quad_perm:[1,0,3,2] row_mask:0xf bank_mask:0xf
    s_nop 0
    v_add_f32_dpp v158, v158, v158 quad_perm:[2,3,0,1] row_mask:0xf bank_mask:0xf
    v_add_f32_dpp v159, v159, v159 quad_perm:[2,3,0,1] row_mask:0xf bank_mask:0xf
    s_nop 0
    v_add_f32_dpp v158, v158, v158 row_half_mirror row_mask:0xf bank_mask:0xf
    v_add_f32_dpp v159, v159, v159 row_half_mirror row_mask:0xf bank_mask:0xf
    v_mul_f32 v158, 0x3ae38e39, v158
    v_mul_f32 v159, 0x3ae38e39, v159
    v_fma_f32 v159, -v158, v158, v159
    v_max_f32 v159, 0, v159
    v_cvt_pk_bf16_f32 v221, v158, v159
    v_lshlrev_b32 v159, 16, v221
    v_and_b32 v221, v248, v221
    v_add_f32 v221, 0x3727c5ac, v221
    v_cvt_pk_bf16_f32 v221, v221, v221
    v_and_b32 v221, v248, v221
    v_sqrt_f32 v221, v221
    s_nop 0
    v_cvt_pk_bf16_f32 v221, v221, v221
    v_and_b32 v221, v248, v221
    v_rcp_f32 v158, v221
    s_nop 0
    v_mul_f32_e64 v159, -v159, v158
    v_lshlrev_b32 v180, 16, v80
    v_and_b32 v181, v248, v80
    v_lshlrev_b32 v182, 16, v81
    v_and_b32 v183, v248, v81
    v_lshlrev_b32 v184, 16, v82
    v_and_b32 v185, v248, v82
    v_lshlrev_b32 v186, 16, v83
    v_and_b32 v187, v248, v83
    v_pk_fma_f32 v[180:181], v[180:181], v[158:159], v[158:159] op_sel:[0,0,1] op_sel_hi:[1,0,1]
    v_pk_fma_f32 v[182:183], v[182:183], v[158:159], v[158:159] op_sel:[0,0,1] op_sel_hi:[1,0,1]
    v_pk_fma_f32 v[184:185], v[184:185], v[158:159], v[158:159] op_sel:[0,0,1] op_sel_hi:[1,0,1]
    v_pk_fma_f32 v[186:187], v[186:187], v[158:159], v[158:159] op_sel:[0,0,1] op_sel_hi:[1,0,1]
    v_cvt_pk_bf16_f32 v80, v180, v181
    v_cvt_pk_bf16_f32 v81, v182, v183
    v_cvt_pk_bf16_f32 v82, v184, v185
    v_cvt_pk_bf16_f32 v83, v186, v187
    ds_write_b128 v153, v[80:83] offset:0
    s_add_u32 m0, s33, 40960
    s_nop 0
    buffer_load_dwordx4 v240, s[16:19], s35 offen  lds
    s_add_u32 s35, s35, s37
    v_lshlrev_b32 v180, 16, v88
    v_and_b32 v181, v248, v88
    v_lshlrev_b32 v182, 16, v89
    v_and_b32 v183, v248, v89
    v_lshlrev_b32 v184, 16, v90
    v_and_b32 v185, v248, v90
    v_lshlrev_b32 v186, 16, v91
    v_and_b32 v187, v248, v91
    v_pk_fma_f32 v[180:181], v[180:181], v[158:159], v[158:159] op_sel:[0,0,1] op_sel_hi:[1,0,1]
    v_pk_fma_f32 v[182:183], v[182:183], v[158:159], v[158:159] op_sel:[0,0,1] op_sel_hi:[1,0,1]
    v_pk_fma_f32 v[184:185], v[184:185], v[158:159], v[158:159] op_sel:[0,0,1] op_sel_hi:[1,0,1]
    v_pk_fma_f32 v[186:187], v[186:187], v[158:159], v[158:159] op_sel:[0,0,1] op_sel_hi:[1,0,1]
    v_cvt_pk_bf16_f32 v88, v180, v181
    v_cvt_pk_bf16_f32 v89, v182, v183
    v_cvt_pk_bf16_f32 v90, v184, v185
    v_cvt_pk_bf16_f32 v91, v186, v187
    ds_write_b128 v153, v[88:91] offset:16384
    s_add_u32 m0, s33, 49152
    s_nop 0
    buffer_load_dwordx4 v240, s[16:19], s35 offen  lds
    s_add_u32 s35, s35, s37
    v_lshlrev_b32 v180, 16, v96
    v_and_b32 v181, v248, v96
    v_lshlrev_b32 v182, 16, v97
    v_and_b32 v183, v248, v97
    v_lshlrev_b32 v184, 16, v98
    v_and_b32 v185, v248, v98
    v_lshlrev_b32 v186, 16, v99
    v_and_b32 v187, v248, v99
    v_pk_fma_f32 v[180:181], v[180:181], v[158:159], v[158:159] op_sel:[0,0,1] op_sel_hi:[1,0,1]
    v_pk_fma_f32 v[182:183], v[182:183], v[158:159], v[158:159] op_sel:[0,0,1] op_sel_hi:[1,0,1]
    v_pk_fma_f32 v[184:185], v[184:185], v[158:159], v[158:159] op_sel:[0,0,1] op_sel_hi:[1,0,1]
    v_pk_fma_f32 v[186:187], v[186:187], v[158:159], v[158:159] op_sel:[0,0,1] op_sel_hi:[1,0,1]
    v_cvt_pk_bf16_f32 v96, v180, v181
    v_cvt_pk_bf16_f32 v97, v182, v183
    v_cvt_pk_bf16_f32 v98, v184, v185
    v_cvt_pk_bf16_f32 v99, v186, v187
    ds_write_b128 v153, v[96:99] offset:32768
    s_add_u32 m0, s33, 57344
    s_nop 0
    buffer_load_dwordx4 v240, s[16:19], s35 offen  lds
    s_add_u32 s35, s35, s37
    v_lshlrev_b32 v180, 16, v104
    v_and_b32 v181, v248, v104
    v_lshlrev_b32 v182, 16, v105
    v_and_b32 v183, v248, v105
    v_lshlrev_b32 v184, 16, v106
    v_and_b32 v185, v248, v106
    v_lshlrev_b32 v186, 16, v107
    v_and_b32 v187, v248, v107
    v_pk_fma_f32 v[180:181], v[180:181], v[158:159], v[158:159] op_sel:[0,0,1] op_sel_hi:[1,0,1]
    v_pk_fma_f32 v[182:183], v[182:183], v[158:159], v[158:159] op_sel:[0,0,1] op_sel_hi:[1,0,1]
    v_pk_fma_f32 v[184:185], v[184:185], v[158:159], v[158:159] op_sel:[0,0,1] op_sel_hi:[1,0,1]
    v_pk_fma_f32 v[186:187], v[186:187], v[158:159], v[158:159] op_sel:[0,0,1] op_sel_hi:[1,0,1]
    v_cvt_pk_bf16_f32 v104, v180, v181
    v_cvt_pk_bf16_f32 v105, v182, v183
    v_cvt_pk_bf16_f32 v106, v184, v185
    v_cvt_pk_bf16_f32 v107, v186, v187
    ds_write_b128 v153, v[104:107] offset:49152
    s_add_u32 m0, s33, 65536
    s_nop 0
    buffer_load_dwordx4 v240, s[16:19], s35 offen  lds
    s_add_u32 s35, s35, s37
    v_lshlrev_b32 v180, 16, v112
    v_and_b32 v181, v248, v112
    v_lshlrev_b32 v182, 16, v113
    v_and_b32 v183, v248, v113
    v_lshlrev_b32 v184, 16, v114
    v_and_b32 v185, v248, v114
    v_lshlrev_b32 v186, 16, v115
    v_and_b32 v187, v248, v115
    v_pk_fma_f32 v[180:181], v[180:181], v[158:159], v[158:159] op_sel:[0,0,1] op_sel_hi:[1,0,1]
    v_pk_fma_f32 v[182:183], v[182:183], v[158:159], v[158:159] op_sel:[0,0,1] op_sel_hi:[1,0,1]
    v_pk_fma_f32 v[184:185], v[184:185], v[158:159], v[158:159] op_sel:[0,0,1] op_sel_hi:[1,0,1]
    v_pk_fma_f32 v[186:187], v[186:187], v[158:159], v[158:159] op_sel:[0,0,1] op_sel_hi:[1,0,1]
    v_cvt_pk_bf16_f32 v112, v180, v181
    v_cvt_pk_bf16_f32 v113, v182, v183
    v_cvt_pk_bf16_f32 v114, v184, v185
    v_cvt_pk_bf16_f32 v115, v186, v187
    s_mov_b32 s16, s100
    s_mov_b32 s17, s101
    s_mov_b32 s18, s88
    s_mov_b32 s35, s89
    s_lshl_b32 s37, s3, 6
    v_mul_u32_u24 v240, s3, v241
    v_add_u32 v240, v240, v242
    v_lshlrev_b32 v180, 16, v120
    v_and_b32 v181, v248, v120
    v_lshlrev_b32 v182, 16, v121
    v_and_b32 v183, v248, v121
    v_lshlrev_b32 v184, 16, v122
    v_and_b32 v185, v248, v122
    v_lshlrev_b32 v186, 16, v123
    v_and_b32 v187, v248, v123
    v_pk_fma_f32 v[180:181], v[180:181], v[158:159], v[158:159] op_sel:[0,0,1] op_sel_hi:[1,0,1]
    v_pk_fma_f32 v[182:183], v[182:183], v[158:159], v[158:159] op_sel:[0,0,1] op_sel_hi:[1,0,1]
    v_pk_fma_f32 v[184:185], v[184:185], v[158:159], v[158:159] op_sel:[0,0,1] op_sel_hi:[1,0,1]
    v_pk_fma_f32 v[186:187], v[186:187], v[158:159], v[158:159] op_sel:[0,0,1] op_sel_hi:[1,0,1]
    v_cvt_pk_bf16_f32 v120, v180, v181
    v_cvt_pk_bf16_f32 v121, v182, v183
    v_cvt_pk_bf16_f32 v122, v184, v185
    v_cvt_pk_bf16_f32 v123, v186, v187
    s_add_u32 m0, s33, 73728
    s_nop 0
    buffer_load_dwordx4 v239, s[12:15], s34 offen  lds
    s_add_u32 s34, s34, s36
    v_lshlrev_b32 v180, 16, v128
    v_and_b32 v181, v248, v128
    v_lshlrev_b32 v182, 16, v129
    v_and_b32 v183, v248, v129
    v_lshlrev_b32 v184, 16, v130
    v_and_b32 v185, v248, v130
    v_lshlrev_b32 v186, 16, v131
    v_and_b32 v187, v248, v131
    v_pk_fma_f32 v[180:181], v[180:181], v[158:159], v[158:159] op_sel:[0,0,1] op_sel_hi:[1,0,1]
    v_pk_fma_f32 v[182:183], v[182:183], v[158:159], v[158:159] op_sel:[0,0,1] op_sel_hi:[1,0,1]
    v_pk_fma_f32 v[184:185], v[184:185], v[158:159], v[158:159] op_sel:[0,0,1] op_sel_hi:[1,0,1]
    v_pk_fma_f32 v[186:187], v[186:187], v[158:159], v[158:159] op_sel:[0,0,1] op_sel_hi:[1,0,1]
    v_cvt_pk_bf16_f32 v128, v180, v181
    v_cvt_pk_bf16_f32 v129, v182, v183
    v_cvt_pk_bf16_f32 v130, v184, v185
    v_cvt_pk_bf16_f32 v131, v186, v187
    s_add_u32 m0, s33, 81920
    s_nop 0
    buffer_load_dwordx4 v239, s[12:15], s34 offen  lds
    s_add_u32 s34, s34, s36
    v_lshlrev_b32 v180, 16, v136
    v_and_b32 v181, v248, v136
    v_lshlrev_b32 v182, 16, v137
    v_and_b32 v183, v248, v137
    v_lshlrev_b32 v184, 16, v138
    v_and_b32 v185, v248, v138
    v_lshlrev_b32 v186, 16, v139
    v_and_b32 v187, v248, v139
    v_pk_fma_f32 v[180:181], v[180:181], v[158:159], v[158:159] op_sel:[0,0,1] op_sel_hi:[1,0,1]
    v_pk_fma_f32 v[182:183], v[182:183], v[158:159], v[158:159] op_sel:[0,0,1] op_sel_hi:[1,0,1]
    v_pk_fma_f32 v[184:185], v[184:185], v[158:159], v[158:159] op_sel:[0,0,1] op_sel_hi:[1,0,1]
    v_pk_fma_f32 v[186:187], v[186:187], v[158:159], v[158:159] op_sel:[0,0,1] op_sel_hi:[1,0,1]
    v_cvt_pk_bf16_f32 v136, v180, v181
    v_cvt_pk_bf16_f32 v137, v182, v183
    v_cvt_pk_bf16_f32 v138, v184, v185
    v_cvt_pk_bf16_f32 v139, v186, v187
    s_add_u32 m0, s33, 90112
    s_nop 0
    buffer_load_dwordx4 v239, s[12:15], s34 offen  lds
    s_add_u32 s34, s34, s36
    v_lshlrev_b32 v180, 16, v144
    v_and_b32 v181, v248, v144
    v_lshlrev_b32 v182, 16, v145
    v_and_b32 v183, v248, v145
    v_lshlrev_b32 v184, 16, v146
    v_and_b32 v185, v248, v146
    v_lshlrev_b32 v186, 16, v147
    v_and_b32 v187, v248, v147
    v_pk_fma_f32 v[180:181], v[180:181], v[158:159], v[158:159] op_sel:[0,0,1] op_sel_hi:[1,0,1]
    v_pk_fma_f32 v[182:183], v[182:183], v[158:159], v[158:159] op_sel:[0,0,1] op_sel_hi:[1,0,1]
    v_pk_fma_f32 v[184:185], v[184:185], v[158:159], v[158:159] op_sel:[0,0,1] op_sel_hi:[1,0,1]
    v_pk_fma_f32 v[186:187], v[186:187], v[158:159], v[158:159] op_sel:[0,0,1] op_sel_hi:[1,0,1]
    v_cvt_pk_bf16_f32 v144, v180, v181
    v_cvt_pk_bf16_f32 v145, v182, v183
    v_cvt_pk_bf16_f32 v146, v184, v185
    v_cvt_pk_bf16_f32 v147, v186, v187
    s_waitcnt lgkmcnt(0)
    s_waitcnt vmcnt(9)
    s_barrier
    ds_read_b128 v[4:7], v148 offset:0
    ds_read_b128 v[8:11], v149 offset:0
    ds_read_b128 v[12:15], v150 offset:0
    ds_read_b128 v[16:19], v151 offset:0
    ds_read_b128 v[20:23], v148 offset:16384
    ds_read_b128 v[24:27], v149 offset:16384
    ds_read_b128 v[28:31], v150 offset:16384
    ds_read_b128 v[32:35], v151 offset:16384
    ds_read_b128 v[36:39], v148 offset:32768
    ds_read_b128 v[40:43], v149 offset:32768
    ds_read_b128 v[44:47], v150 offset:32768
    ds_read_b128 v[48:51], v151 offset:32768
    ds_read_b128 v[52:55], v148 offset:49152
    ds_read_b128 v[56:59], v149 offset:49152
    ds_read_b128 v[60:63], v150 offset:49152
    ds_read_b128 v[64:67], v151 offset:49152
    ds_read_b64_tr_b16 v[196:197], v236 offset:0
    ds_read_b64_tr_b16 v[198:199], v236 offset:512
    ds_read_b64_tr_b16 v[200:201], v237 offset:0
    ds_read_b64_tr_b16 v[202:203], v237 offset:512
    ds_read_b64_tr_b16 v[204:205], v236 offset:4096
    ds_read_b64_tr_b16 v[206:207], v236 offset:4608
    ds_read_b64_tr_b16 v[208:209], v237 offset:4096
    ds_read_b64_tr_b16 v[210:211], v237 offset:4608
    ds_read_b64_tr_b16 v[212:213], v236 offset:8192
    ds_read_b64_tr_b16 v[214:215], v236 offset:8704
    s_lshl_b32 s41, s2, 3
    s_add_u32 s41, s41, s28
    v_lshlrev_b32 v223, 7, v0
    s_mov_b32 s4, s52
    s_mov_b32 s5, s53
    s_mov_b32 s6, 5308416
    s_mov_b32 s7, 0x20000
    s_mov_b32 s85, 0
    s_cmp_ge_u32 s41, 648
    s_cselect_b32 s4, s54, s4
    s_cselect_b32 s5, s55, s5
    s_cselect_b32 s85, 648, 0
    s_cmp_ge_u32 s41, 1296
    s_cselect_b32 s4, s50, s4
    s_cselect_b32 s5, s51, s5
    s_cselect_b32 s6, 1990656, s6
    s_cselect_b32 s85, 1296, s85
    s_cmp_ge_u32 s41, 1539
    s_cselect_b32 s4, s56, s4
    s_cselect_b32 s5, s57, s5
    s_cselect_b32 s6, 0, s6
    s_cselect_b32 s85, 1539, s85
    s_sub_u32 s42, s41, s85
    s_lshl_b32 s42, s42, 13
    buffer_load_dword v250, v223, s[4:7], s42 offen
    s_cmp_ge_u32 s41, 1539
    s_cselect_b32 s6, s6, 0
    s_add_u32 s42, s42, 4169728
    s_cmp_ge_u32 s41, 1900
    s_cselect_b32 s4, s94, s4
    s_cselect_b32 s5, s95, s5
    s_cselect_b32 s6, 0, s6
    s_cselect_b32 s85, 7127040, 0
    s_sub_u32 s42, s42, s85
    buffer_load_dword v251, v223, s[4:7], s42 offen
    s_waitcnt lgkmcnt(8)
    v_mfma_f32_16x16x32_bf16 v[164:167], v[196:199], v[4:7], 0
    ds_read_b64_tr_b16 v[216:217], v237 offset:8192
    v_mfma_f32_16x16x32_bf16 v[172:175], v[196:199], v[8:11], 0
    ds_read_b64_tr_b16 v[218:219], v237 offset:8704
    s_waitcnt lgkmcnt(8)
    v_mfma_f32_16x16x32_bf16 v[168:171], v[200:203], v[4:7], 0
    ds_read_b64_tr_b16 v[196:197], v236 offset:12288
    v_mfma_f32_16x16x32_bf16 v[176:179], v[200:203], v[8:11], 0
    ds_read_b64_tr_b16 v[198:199], v236 offset:12800
    s_waitcnt vmcnt(8)
    s_barrier
    s_waitcnt lgkmcnt(8)
    v_mfma_f32_16x16x32_bf16 v[164:167], v[204:207], v[12:15], v[164:167]
    ds_read_b64_tr_b16 v[200:201], v237 offset:12288
    v_mfma_f32_16x16x32_bf16 v[172:175], v[204:207], v[16:19], v[172:175]
    ds_read_b64_tr_b16 v[202:203], v237 offset:12800
    ds_write_b128 v152, v[108:111] offset:0
    s_waitcnt lgkmcnt(9)
    v_mfma_f32_16x16x32_bf16 v[168:171], v[208:211], v[12:15], v[168:171]
    ds_read_b64_tr_b16 v[204:205], v236 offset:16384
    v_mfma_f32_16x16x32_bf16 v[176:179], v[208:211], v[16:19], v[176:179]
    ds_read_b64_tr_b16 v[206:207], v236 offset:16896
    ds_write_b128 v153, v[112:115] offset:0
    s_waitcnt lgkmcnt(10)
    v_mfma_f32_16x16x32_bf16 v[164:167], v[212:215], v[20:23], v[164:167]
    ds_read_b64_tr_b16 v[208:209], v237 offset:16384
    v_mfma_f32_16x16x32_bf16 v[172:175], v[212:215], v[24:27], v[172:175]
    ds_read_b64_tr_b16 v[210:211], v237 offset:16896
    ds_write_b128 v152, v[116:119] offset:16384
    s_waitcnt lgkmcnt(11)
    v_mfma_f32_16x16x32_bf16 v[168:171], v[216:219], v[20:23], v[168:171]
    ds_read_b64_tr_b16 v[212:213], v236 offset:20480
    v_mfma_f32_16x16x32_bf16 v[176:179], v[216:219], v[24:27], v[176:179]
    ds_read_b64_tr_b16 v[214:215], v236 offset:20992
    ds_write_b128 v153, v[120:123] offset:16384
    s_waitcnt lgkmcnt(12)
    v_mfma_f32_16x16x32_bf16 v[164:167], v[196:199], v[28:31], v[164:167]
    ds_read_b64_tr_b16 v[216:217], v237 offset:20480
    v_mfma_f32_16x16x32_bf16 v[172:175], v[196:199], v[32:35], v[172:175]
    ds_read_b64_tr_b16 v[218:219], v237 offset:20992
    ds_write_b128 v152, v[124:127] offset:32768
    s_waitcnt lgkmcnt(13)
    v_mfma_f32_16x16x32_bf16 v[168:171], v[200:203], v[28:31], v[168:171]
    ds_read_b64_tr_b16 v[196:197], v236 offset:24576
    v_mfma_f32_16x16x32_bf16 v[176:179], v[200:203], v[32:35], v[176:179]
    ds_read_b64_tr_b16 v[198:199], v236 offset:25088
    ds_write_b128 v153, v[128:131] offset:32768
    s_waitcnt lgkmcnt(13)
    v_mfma_f32_16x16x32_bf16 v[164:167], v[204:207], v[36:39], v[164:167]
    ds_read_b64_tr_b16 v[200:201], v237 offset:24576
    v_mfma_f32_16x16x32_bf16 v[172:175], v[204:207], v[40:43], v[172:175]
    ds_read_b64_tr_b16 v[202:203], v237 offset:25088
    ds_write_b128 v152, v[132:135] offset:49152
    s_waitcnt lgkmcnt(13)
    v_mfma_f32_16x16x32_bf16 v[168:171], v[208:211], v[36:39], v[168:171]
    ds_read_b64_tr_b16 v[204:205], v236 offset:28672
    v_mfma_f32_16x16x32_bf16 v[176:179], v[208:211], v[40:43], v[176:179]
    ds_read_b64_tr_b16 v[206:207], v236 offset:29184
    ds_write_b128 v153, v[136:139] offset:49152
    s_waitcnt lgkmcnt(13)
    v_mfma_f32_16x16x32_bf16 v[164:167], v[212:215], v[44:47], v[164:167]
    ds_read_b64_tr_b16 v[208:209], v237 offset:28672
    v_mfma_f32_16x16x32_bf16 v[172:175], v[212:215], v[48:51], v[172:175]
    ds_read_b64_tr_b16 v[210:211], v237 offset:29184
    s_waitcnt lgkmcnt(12)
    v_mfma_f32_16x16x32_bf16 v[168:171], v[216:219], v[44:47], v[168:171]
    ds_read_b64_tr_b16 v[212:213], v236 offset:32768
    v_mfma_f32_16x16x32_bf16 v[176:179], v[216:219], v[48:51], v[176:179]
    ds_read_b64_tr_b16 v[214:215], v236 offset:33280
    s_waitcnt lgkmcnt(11)
    v_mfma_f32_16x16x32_bf16 v[164:167], v[196:199], v[52:55], v[164:167]
    ds_read_b64_tr_b16 v[216:217], v237 offset:32768
    v_mfma_f32_16x16x32_bf16 v[172:175], v[196:199], v[56:59], v[172:175]
    ds_read_b64_tr_b16 v[218:219], v237 offset:33280
    s_waitcnt lgkmcnt(6)
    s_waitcnt vmcnt(5)
    s_barrier
    ds_read_b128 v[68:71], v148 offset:0
    ds_read_b128 v[72:75], v149 offset:0
    ds_read_b128 v[76:79], v150 offset:0
    ds_read_b128 v[80:83], v151 offset:0
    ds_read_b128 v[84:87], v148 offset:16384
    ds_read_b128 v[88:91], v149 offset:16384
    ds_read_b128 v[92:95], v150 offset:16384
    ds_read_b128 v[96:99], v151 offset:16384
    ds_read_b128 v[100:103], v148 offset:32768
    ds_read_b128 v[104:107], v149 offset:32768
    ds_read_b128 v[108:111], v150 offset:32768
    ds_read_b128 v[112:115], v151 offset:32768
    ds_read_b128 v[116:119], v148 offset:49152
    ds_read_b128 v[120:123], v149 offset:49152
    ds_read_b128 v[124:127], v150 offset:49152
    ds_read_b128 v[128:131], v151 offset:49152
    v_mfma_f32_16x16x32_bf16 v[168:171], v[200:203], v[52:55], v[168:171]
    ds_read_b64_tr_b16 v[196:197], v236 offset:36864
    v_mfma_f32_16x16x32_bf16 v[176:179], v[200:203], v[56:59], v[176:179]
    ds_read_b64_tr_b16 v[198:199], v236 offset:37376
    s_add_u32 m0, s33, 0
    s_nop 0
    buffer_load_dwordx4 v239, s[12:15], s34 offen  lds
    s_add_u32 s34, s34, s36
    v_mfma_f32_16x16x32_bf16 v[164:167], v[204:207], v[60:63], v[164:167]
    ds_read_b64_tr_b16 v[200:201], v237 offset:36864
    v_mfma_f32_16x16x32_bf16 v[172:175], v[204:207], v[64:67], v[172:175]
    ds_read_b64_tr_b16 v[202:203], v237 offset:37376
    s_add_u32 m0, s33, 8192
    s_nop 0
    buffer_load_dwordx4 v239, s[12:15], s34 offen  lds
    s_add_u32 s34, s34, s36
    s_waitcnt lgkmcnt(15)
    v_mfma_f32_16x16x32_bf16 v[168:171], v[208:211], v[60:63], v[168:171]
    ds_read_b64_tr_b16 v[204:205], v236 offset:40960
    v_mfma_f32_16x16x32_bf16 v[176:179], v[208:211], v[64:67], v[176:179]
    ds_read_b64_tr_b16 v[206:207], v236 offset:41472
    s_add_u32 m0, s33, 16384
    s_nop 0
    buffer_load_dwordx4 v239, s[12:15], s34 offen  lds
    s_add_u32 s34, s34, s36
    v_mfma_f32_16x16x32_bf16 v[164:167], v[212:215], v[68:71], v[164:167]
    ds_read_b64_tr_b16 v[208:209], v237 offset:40960
    v_mfma_f32_16x16x32_bf16 v[172:175], v[212:215], v[72:75], v[172:175]
    ds_read_b64_tr_b16 v[210:211], v237 offset:41472
    s_barrier
    v_mfma_f32_16x16x32_bf16 v[168:171], v[216:219], v[68:71], v[168:171]
    ds_read_b64_tr_b16 v[212:213], v236 offset:45056
    v_mfma_f32_16x16x32_bf16 v[176:179], v[216:219], v[72:75], v[176:179]
    ds_read_b64_tr_b16 v[214:215], v236 offset:45568
    ds_write_b128 v152, v[140:143] offset:0
    s_waitcnt lgkmcnt(9)
    v_mfma_f32_16x16x32_bf16 v[164:167], v[196:199], v[76:79], v[164:167]
    ds_read_b64_tr_b16 v[216:217], v237 offset:45056
    v_mfma_f32_16x16x32_bf16 v[172:175], v[196:199], v[80:83], v[172:175]
    ds_read_b64_tr_b16 v[218:219], v237 offset:45568
    ds_write_b128 v153, v[144:147] offset:0
    s_waitcnt lgkmcnt(10)
    v_mfma_f32_16x16x32_bf16 v[168:171], v[200:203], v[76:79], v[168:171]
    v_add_u32 v236, 49152, v236
    v_add_u32 v237, 49152, v237
    ds_read_b64_tr_b16 v[196:197], v236 offset:0
    v_mfma_f32_16x16x32_bf16 v[176:179], v[200:203], v[80:83], v[176:179]
    ds_read_b64_tr_b16 v[198:199], v236 offset:512
    s_waitcnt lgkmcnt(10)
    v_mfma_f32_16x16x32_bf16 v[164:167], v[204:207], v[84:87], v[164:167]
    ds_read_b64_tr_b16 v[200:201], v237 offset:0
    v_mfma_f32_16x16x32_bf16 v[172:175], v[204:207], v[88:91], v[172:175]
    ds_read_b64_tr_b16 v[202:203], v237 offset:512
    s_waitcnt lgkmcnt(10)
    v_mfma_f32_16x16x32_bf16 v[168:171], v[208:211], v[84:87], v[168:171]
    ds_read_b64_tr_b16 v[204:205], v236 offset:4096
    v_mfma_f32_16x16x32_bf16 v[176:179], v[208:211], v[88:91], v[176:179]
    ds_read_b64_tr_b16 v[206:207], v236 offset:4608
    s_waitcnt lgkmcnt(10)
    v_mfma_f32_16x16x32_bf16 v[164:167], v[212:215], v[92:95], v[164:167]
    ds_read_b64_tr_b16 v[208:209], v237 offset:4096
    v_mfma_f32_16x16x32_bf16 v[172:175], v[212:215], v[96:99], v[172:175]
    ds_read_b64_tr_b16 v[210:211], v237 offset:4608
    s_waitcnt lgkmcnt(9)
    v_mfma_f32_16x16x32_bf16 v[168:171], v[216:219], v[92:95], v[168:171]
    ds_read_b64_tr_b16 v[212:213], v236 offset:8192
    v_mfma_f32_16x16x32_bf16 v[176:179], v[216:219], v[96:99], v[176:179]
    ds_read_b64_tr_b16 v[214:215], v236 offset:8704
    s_waitcnt lgkmcnt(10)
    s_waitcnt vmcnt(5)
    s_barrier
    ds_read_b128 v[132:135], v148 offset:0
    ds_read_b128 v[136:139], v149 offset:0
    ds_read_b128 v[140:143], v150 offset:0
    ds_read_b128 v[144:147], v151 offset:0
    s_waitcnt lgkmcnt(12)
    v_mfma_f32_16x16x32_bf16 v[164:167], v[196:199], v[100:103], v[164:167]
    ds_read_b64_tr_b16 v[216:217], v237 offset:8192
    v_mfma_f32_16x16x32_bf16 v[172:175], v[196:199], v[104:107], v[172:175]
    ds_read_b64_tr_b16 v[218:219], v237 offset:8704
    s_add_u32 m0, s33, 24576
    s_nop 0
    buffer_load_dwordx4 v239, s[12:15], s34 offen  lds
    s_add_u32 s34, s34, s36
    s_waitcnt lgkmcnt(12)
    v_mfma_f32_16x16x32_bf16 v[168:171], v[200:203], v[100:103], v[168:171]
    ds_read_b64_tr_b16 v[196:197], v236 offset:12288
    v_mfma_f32_16x16x32_bf16 v[176:179], v[200:203], v[104:107], v[176:179]
    ds_read_b64_tr_b16 v[198:199], v236 offset:12800
    s_add_u32 m0, s33, 32768
    s_nop 0
    buffer_load_dwordx4 v239, s[12:15], s34 offen  lds
    s_add_u32 s34, s34, s36
    s_waitcnt lgkmcnt(12)
    v_mfma_f32_16x16x32_bf16 v[164:167], v[204:207], v[108:111], v[164:167]
    ds_read_b64_tr_b16 v[200:201], v237 offset:12288
    v_mfma_f32_16x16x32_bf16 v[172:175], v[204:207], v[112:115], v[172:175]
    ds_read_b64_tr_b16 v[202:203], v237 offset:12800
    s_waitcnt lgkmcnt(12)
    v_mfma_f32_16x16x32_bf16 v[168:171], v[208:211], v[108:111], v[168:171]
    ds_read_b64_tr_b16 v[204:205], v236 offset:16384
    v_mfma_f32_16x16x32_bf16 v[176:179], v[208:211], v[112:115], v[176:179]
    ds_read_b64_tr_b16 v[206:207], v236 offset:16896
    s_add_u32 m0, s33, 40960
    s_nop 0
    buffer_load_dwordx4 v239, s[12:15], s34 offen  lds
    s_add_u32 s34, s34, s36
    s_waitcnt lgkmcnt(12)
    v_mfma_f32_16x16x32_bf16 v[164:167], v[212:215], v[116:119], v[164:167]
    ds_read_b64_tr_b16 v[208:209], v237 offset:16384
    v_mfma_f32_16x16x32_bf16 v[172:175], v[212:215], v[120:123], v[172:175]
    ds_read_b64_tr_b16 v[210:211], v237 offset:16896
    s_waitcnt lgkmcnt(10)
    s_barrier
    s_waitcnt lgkmcnt(8)
    v_mfma_f32_16x16x32_bf16 v[168:171], v[216:219], v[116:119], v[168:171]
    ds_read_b64_tr_b16 v[212:213], v236 offset:20480
    v_mfma_f32_16x16x32_bf16 v[176:179], v[216:219], v[120:123], v[176:179]
    ds_read_b64_tr_b16 v[214:215], v236 offset:20992
    s_add_u32 m0, s33, 98304
    s_nop 0
    buffer_load_dwordx4 v240, s[16:19], s35 offen  lds
    s_add_u32 s35, s35, s37
    s_waitcnt lgkmcnt(8)
    v_mfma_f32_16x16x32_bf16 v[164:167], v[196:199], v[124:127], v[164:167]
    ds_read_b64_tr_b16 v[216:217], v237 offset:20480
    v_mfma_f32_16x16x32_bf16 v[172:175], v[196:199], v[128:131], v[172:175]
    ds_read_b64_tr_b16 v[218:219], v237 offset:20992
    s_add_u32 m0, s33, 106496
    s_nop 0
    buffer_load_dwordx4 v240, s[16:19], s35 offen  lds
    s_add_u32 s35, s35, s37
    s_waitcnt lgkmcnt(8)
    v_mfma_f32_16x16x32_bf16 v[168:171], v[200:203], v[124:127], v[168:171]
    ds_read_b64_tr_b16 v[196:197], v236 offset:24576
    v_mfma_f32_16x16x32_bf16 v[176:179], v[200:203], v[128:131], v[176:179]
    ds_read_b64_tr_b16 v[198:199], v236 offset:25088
    s_add_u32 m0, s33, 114688
    s_nop 0
    buffer_load_dwordx4 v240, s[16:19], s35 offen  lds
    s_add_u32 s35, s35, s37
    s_waitcnt lgkmcnt(8)
    v_mfma_f32_16x16x32_bf16 v[164:167], v[204:207], v[132:135], v[164:167]
    ds_read_b64_tr_b16 v[200:201], v237 offset:24576
    v_mfma_f32_16x16x32_bf16 v[172:175], v[204:207], v[136:139], v[172:175]
    ds_read_b64_tr_b16 v[202:203], v237 offset:25088
    s_add_u32 m0, s33, 122880
    s_nop 0
    buffer_load_dwordx4 v240, s[16:19], s35 offen  lds
    s_add_u32 s35, s35, s37
    s_waitcnt lgkmcnt(8)
    v_mfma_f32_16x16x32_bf16 v[168:171], v[208:211], v[132:135], v[168:171]
    ds_read_b64_tr_b16 v[204:205], v236 offset:28672
    v_mfma_f32_16x16x32_bf16 v[176:179], v[208:211], v[136:139], v[176:179]
    ds_read_b64_tr_b16 v[206:207], v236 offset:29184
    s_add_u32 m0, s33, 131072
    s_nop 0
    buffer_load_dwordx4 v240, s[16:19], s35 offen  lds
    s_add_u32 s35, s35, s37
    s_waitcnt lgkmcnt(8)
    v_mfma_f32_16x16x32_bf16 v[164:167], v[212:215], v[140:143], v[164:167]
    ds_read_b64_tr_b16 v[208:209], v237 offset:28672
    v_mfma_f32_16x16x32_bf16 v[172:175], v[212:215], v[144:147], v[172:175]
    ds_read_b64_tr_b16 v[210:211], v237 offset:29184
    s_add_u32 m0, s33, 139264
    s_nop 0
    buffer_load_dwordx4 v240, s[16:19], s35 offen  lds
    s_add_u32 s35, s35, s37
    s_waitcnt lgkmcnt(8)
    v_mfma_f32_16x16x32_bf16 v[168:171], v[216:219], v[140:143], v[168:171]
    ds_read_b64_tr_b16 v[212:213], v236 offset:32768
    v_mfma_f32_16x16x32_bf16 v[176:179], v[216:219], v[144:147], v[176:179]
    ds_read_b64_tr_b16 v[214:215], v236 offset:33280
    s_cmp_ge_u32 s32, 11
    s_cbranch_scc1 K1_BT
    s_cmp_ge_u32 s32, 10
    s_cbranch_scc1 K1_B1V
    s_cmp_ge_u32 s32, 8
    s_cbranch_scc1 K1_B1K
    v_mul_f32 v164, s45, v164
    v_mul_f32 v165, s45, v165
    v_mul_f32 v166, s45, v166
    v_mul_f32 v167, s45, v167
    v_cvt_pk_bf16_f32 v228, v164, v165
    v_cvt_pk_bf16_f32 v229, v166, v167
    s_add_u32 s42, s44, 0
    buffer_store_dwordx2 v[228:229], v246, s[20:23], s42 offen offset:0 sc1
    v_mul_f32 v168, s45, v168
    v_mul_f32 v169, s45, v169
    v_mul_f32 v170, s45, v170
    v_mul_f32 v171, s45, v171
    v_cvt_pk_bf16_f32 v230, v168, v169
    v_cvt_pk_bf16_f32 v231, v170, v171
    s_add_u32 s42, s44, 65536
    buffer_store_dwordx2 v[230:231], v246, s[20:23], s42 offen offset:0 sc1
    v_mul_f32 v172, s45, v172
    v_mul_f32 v173, s45, v173
    v_mul_f32 v174, s45, v174
    v_mul_f32 v175, s45, v175
    v_cvt_pk_bf16_f32 v232, v172, v173
    v_cvt_pk_bf16_f32 v233, v174, v175
    s_add_u32 s42, s44, 0
    buffer_store_dwordx2 v[232:233], v246, s[20:23], s42 offen offset:128 sc1
    v_mul_f32 v176, s45, v176
    v_mul_f32 v177, s45, v177
    v_mul_f32 v178, s45, v178
    v_mul_f32 v179, s45, v179
    v_cvt_pk_bf16_f32 v234, v176, v177
    v_cvt_pk_bf16_f32 v235, v178, v179
    s_add_u32 s42, s44, 65536
    buffer_store_dwordx2 v[234:235], v246, s[20:23], s42 offen offset:128 sc1
    s_branch K1_PRE
K1_B1K:
    s_waitcnt lgkmcnt(8)
    v_mfma_f32_16x16x32_bf16 v[148:151], v[196:199], v[4:7], 0
    s_waitcnt vmcnt(9)
    s_barrier
    ds_read_b64_tr_b16 v[216:217], v237 offset:32768
    v_mfma_f32_16x16x32_bf16 v[156:159], v[196:199], v[8:11], 0
    ds_read_b64_tr_b16 v[218:219], v237 offset:33280
    s_waitcnt lgkmcnt(8)
    v_mfma_f32_16x16x32_bf16 v[152:155], v[200:203], v[4:7], 0
    ds_read_b64_tr_b16 v[196:197], v236 offset:36864
    v_mfma_f32_16x16x32_bf16 v[160:163], v[200:203], v[8:11], 0
    ds_read_b64_tr_b16 v[198:199], v236 offset:37376
    s_add_u32 m0, s33, 49152
    s_nop 0
    buffer_load_dwordx4 v240, s[16:19], s35 offen  lds
    s_add_u32 s35, s35, s37
    s_waitcnt lgkmcnt(8)
    v_mfma_f32_16x16x32_bf16 v[148:151], v[204:207], v[12:15], v[148:151]
    ds_read_b64_tr_b16 v[200:201], v237 offset:36864
    v_mfma_f32_16x16x32_bf16 v[156:159], v[204:207], v[16:19], v[156:159]
    ds_read_b64_tr_b16 v[202:203], v237 offset:37376
    s_waitcnt lgkmcnt(8)
    v_mfma_f32_16x16x32_bf16 v[152:155], v[208:211], v[12:15], v[152:155]
    ds_read_b64_tr_b16 v[204:205], v236 offset:40960
    v_mfma_f32_16x16x32_bf16 v[160:163], v[208:211], v[16:19], v[160:163]
    ds_read_b64_tr_b16 v[206:207], v236 offset:41472
    v_mul_f32 v164, s45, v164
    v_mul_f32 v165, s45, v165
    s_waitcnt lgkmcnt(8)
    v_mfma_f32_16x16x32_bf16 v[148:151], v[212:215], v[20:23], v[148:151]
    ds_read_b64_tr_b16 v[208:209], v237 offset:40960
    v_mfma_f32_16x16x32_bf16 v[156:159], v[212:215], v[24:27], v[156:159]
    ds_read_b64_tr_b16 v[210:211], v237 offset:41472
    v_mul_f32 v166, s45, v166
    v_mul_f32 v167, s45, v167
    s_waitcnt lgkmcnt(8)
    v_mfma_f32_16x16x32_bf16 v[152:155], v[216:219], v[20:23], v[152:155]
    ds_read_b64_tr_b16 v[212:213], v236 offset:45056
    v_mfma_f32_16x16x32_bf16 v[160:163], v[216:219], v[24:27], v[160:163]
    ds_read_b64_tr_b16 v[214:215], v236 offset:45568
    s_add_u32 m0, s33, 57344
    s_nop 0
    buffer_load_dwordx4 v240, s[16:19], s35 offen  lds
    s_add_u32 s35, s35, s37
    s_waitcnt lgkmcnt(8)
    v_mfma_f32_16x16x32_bf16 v[148:151], v[196:199], v[28:31], v[148:151]
    ds_read_b64_tr_b16 v[216:217], v237 offset:45056
    v_mfma_f32_16x16x32_bf16 v[156:159], v[196:199], v[32:35], v[156:159]
    ds_read_b64_tr_b16 v[218:219], v237 offset:45568
    v_cvt_pk_bf16_f32 v228, v164, v165
    v_cvt_pk_bf16_f32 v229, v166, v167
    s_waitcnt lgkmcnt(8)
    v_mfma_f32_16x16x32_bf16 v[152:155], v[200:203], v[28:31], v[152:155]
    v_add_u32 v236, 4294918144, v236
    v_add_u32 v237, 4294918144, v237
    ds_read_b64_tr_b16 v[196:197], v236 offset:0
    v_mfma_f32_16x16x32_bf16 v[160:163], v[200:203], v[32:35], v[160:163]
    ds_read_b64_tr_b16 v[198:199], v236 offset:512
    s_waitcnt lgkmcnt(8)
    v_mfma_f32_16x16x32_bf16 v[148:151], v[204:207], v[36:39], v[148:151]
    ds_read_b64_tr_b16 v[200:201], v237 offset:0
    v_mfma_f32_16x16x32_bf16 v[156:159], v[204:207], v[40:43], v[156:159]
    ds_read_b64_tr_b16 v[202:203], v237 offset:512
    s_add_u32 s42, s44, 0
    buffer_store_dwordx2 v[228:229], v246, s[20:23], s42 offen offset:0 sc1
    s_waitcnt lgkmcnt(8)
    v_mfma_f32_16x16x32_bf16 v[152:155], v[208:211], v[36:39], v[152:155]
    ds_read_b64_tr_b16 v[204:205], v236 offset:4096
    v_mfma_f32_16x16x32_bf16 v[160:163], v[208:211], v[40:43], v[160:163]
    ds_read_b64_tr_b16 v[206:207], v236 offset:4608
    v_mul_f32 v168, s45, v168
    v_mul_f32 v169, s45, v169
    s_add_u32 m0, s33, 65536
    s_nop 0
    buffer_load_dwordx4 v240, s[16:19], s35 offen  lds
    s_add_u32 s35, s35, s37
    s_waitcnt lgkmcnt(8)
    v_mfma_f32_16x16x32_bf16 v[148:151], v[212:215], v[44:47], v[148:151]
    ds_read_b64_tr_b16 v[208:209], v237 offset:4096
    v_mfma_f32_16x16x32_bf16 v[156:159], v[212:215], v[48:51], v[156:159]
    ds_read_b64_tr_b16 v[210:211], v237 offset:4608
    s_waitcnt lgkmcnt(8)
    v_mfma_f32_16x16x32_bf16 v[152:155], v[216:219], v[44:47], v[152:155]
    ds_read_b64_tr_b16 v[212:213], v236 offset:8192
    v_mfma_f32_16x16x32_bf16 v[160:163], v[216:219], v[48:51], v[160:163]
    ds_read_b64_tr_b16 v[214:215], v236 offset:8704
    v_mul_f32 v170, s45, v170
    v_mul_f32 v171, s45, v171
    s_waitcnt lgkmcnt(8)
    v_mfma_f32_16x16x32_bf16 v[148:151], v[196:199], v[52:55], v[148:151]
    s_waitcnt vmcnt(10)
    s_barrier
    ds_read_b64_tr_b16 v[216:217], v237 offset:8192
    v_mfma_f32_16x16x32_bf16 v[156:159], v[196:199], v[56:59], v[156:159]
    ds_read_b64_tr_b16 v[218:219], v237 offset:8704
    s_mov_b32 s12, s52
    s_mov_b32 s13, s53
    s_mov_b32 s14, 5308416
    s_mov_b32 s34, s40
    s_mov_b32 s36, 589824
    v_mul_u32_u24 v239, 9216, v241
    v_add_u32 v239, v239, v242
    s_waitcnt lgkmcnt(8)
    v_mfma_f32_16x16x32_bf16 v[152:155], v[200:203], v[52:55], v[152:155]
    ds_read_b64_tr_b16 v[196:197], v236 offset:12288
    v_mfma_f32_16x16x32_bf16 v[160:163], v[200:203], v[56:59], v[160:163]
    ds_read_b64_tr_b16 v[198:199], v236 offset:12800
    v_cvt_pk_bf16_f32 v230, v168, v169
    v_cvt_pk_bf16_f32 v231, v170, v171
    s_add_u32 m0, s33, 73728
    s_nop 0
    buffer_load_dwordx4 v239, s[12:15], s34 offen  lds
    s_add_u32 s34, s34, s36
    s_waitcnt lgkmcnt(8)
    v_mfma_f32_16x16x32_bf16 v[148:151], v[204:207], v[60:63], v[148:151]
    ds_read_b64_tr_b16 v[200:201], v237 offset:12288
    v_mfma_f32_16x16x32_bf16 v[156:159], v[204:207], v[64:67], v[156:159]
    ds_read_b64_tr_b16 v[202:203], v237 offset:12800
    s_add_u32 s42, s44, 65536
    buffer_store_dwordx2 v[230:231], v246, s[20:23], s42 offen offset:0 sc1
    s_waitcnt lgkmcnt(8)
    v_mfma_f32_16x16x32_bf16 v[152:155], v[208:211], v[60:63], v[152:155]
    ds_read_b64_tr_b16 v[204:205], v236 offset:16384
    v_mfma_f32_16x16x32_bf16 v[160:163], v[208:211], v[64:67], v[160:163]
    ds_read_b64_tr_b16 v[206:207], v236 offset:16896
    s_waitcnt lgkmcnt(8)
    v_mfma_f32_16x16x32_bf16 v[148:151], v[212:215], v[68:71], v[148:151]
    ds_read_b64_tr_b16 v[208:209], v237 offset:16384
    v_mfma_f32_16x16x32_bf16 v[156:159], v[212:215], v[72:75], v[156:159]
    ds_read_b64_tr_b16 v[210:211], v237 offset:16896
    v_mul_f32 v172, s45, v172
    v_mul_f32 v173, s45, v173
    s_waitcnt lgkmcnt(8)
    v_mfma_f32_16x16x32_bf16 v[152:155], v[216:219], v[68:71], v[152:155]
    ds_read_b64_tr_b16 v[212:213], v236 offset:20480
    v_mfma_f32_16x16x32_bf16 v[160:163], v[216:219], v[72:75], v[160:163]
    ds_read_b64_tr_b16 v[214:215], v236 offset:20992
    s_add_u32 m0, s33, 81920
    s_nop 0
    buffer_load_dwordx4 v239, s[12:15], s34 offen  lds
    s_add_u32 s34, s34, s36
    s_waitcnt lgkmcnt(8)
    v_mfma_f32_16x16x32_bf16 v[148:151], v[196:199], v[76:79], v[148:151]
    ds_read_b64_tr_b16 v[216:217], v237 offset:20480
    v_mfma_f32_16x16x32_bf16 v[156:159], v[196:199], v[80:83], v[156:159]
    ds_read_b64_tr_b16 v[218:219], v237 offset:20992
    v_mul_f32 v174, s45, v174
    v_mul_f32 v175, s45, v175
    s_waitcnt lgkmcnt(8)
    v_mfma_f32_16x16x32_bf16 v[152:155], v[200:203], v[76:79], v[152:155]
    ds_read_b64_tr_b16 v[196:197], v236 offset:24576
    v_mfma_f32_16x16x32_bf16 v[160:163], v[200:203], v[80:83], v[160:163]
    ds_read_b64_tr_b16 v[198:199], v236 offset:25088
    v_cvt_pk_bf16_f32 v232, v172, v173
    v_cvt_pk_bf16_f32 v233, v174, v175
    s_waitcnt lgkmcnt(8)
    v_mfma_f32_16x16x32_bf16 v[148:151], v[204:207], v[84:87], v[148:151]
    ds_read_b64_tr_b16 v[200:201], v237 offset:24576
    v_mfma_f32_16x16x32_bf16 v[156:159], v[204:207], v[88:91], v[156:159]
    ds_read_b64_tr_b16 v[202:203], v237 offset:25088
    s_waitcnt lgkmcnt(8)
    v_mfma_f32_16x16x32_bf16 v[152:155], v[208:211], v[84:87], v[152:155]
    ds_read_b64_tr_b16 v[204:205], v236 offset:28672
    v_mfma_f32_16x16x32_bf16 v[160:163], v[208:211], v[88:91], v[160:163]
    ds_read_b64_tr_b16 v[206:207], v236 offset:29184
    s_add_u32 s42, s44, 0
    buffer_store_dwordx2 v[232:233], v246, s[20:23], s42 offen offset:128 sc1
    s_add_u32 m0, s33, 90112
    s_nop 0
    buffer_load_dwordx4 v239, s[12:15], s34 offen  lds
    s_add_u32 s34, s34, s36
    s_waitcnt lgkmcnt(8)
    v_mfma_f32_16x16x32_bf16 v[148:151], v[212:215], v[92:95], v[148:151]
    ds_read_b64_tr_b16 v[208:209], v237 offset:28672
    v_mfma_f32_16x16x32_bf16 v[156:159], v[212:215], v[96:99], v[156:159]
    ds_read_b64_tr_b16 v[210:211], v237 offset:29184
    s_waitcnt lgkmcnt(8)
    v_mfma_f32_16x16x32_bf16 v[152:155], v[216:219], v[92:95], v[152:155]
    ds_read_b64_tr_b16 v[212:213], v236 offset:32768
    v_mfma_f32_16x16x32_bf16 v[160:163], v[216:219], v[96:99], v[160:163]
    ds_read_b64_tr_b16 v[214:215], v236 offset:33280
    v_mul_f32 v176, s45, v176
    v_mul_f32 v177, s45, v177
    s_waitcnt lgkmcnt(8)
    v_mfma_f32_16x16x32_bf16 v[148:151], v[196:199], v[100:103], v[148:151]
    s_waitcnt vmcnt(12)
    s_barrier
    ds_read_b64_tr_b16 v[216:217], v237 offset:32768
    v_mfma_f32_16x16x32_bf16 v[156:159], v[196:199], v[104:107], v[156:159]
    ds_read_b64_tr_b16 v[218:219], v237 offset:33280
    v_mul_f32 v178, s45, v178
    v_mul_f32 v179, s45, v179
    s_waitcnt lgkmcnt(8)
    v_mfma_f32_16x16x32_bf16 v[152:155], v[200:203], v[100:103], v[152:155]
    ds_read_b64_tr_b16 v[196:197], v236 offset:36864
    v_mfma_f32_16x16x32_bf16 v[160:163], v[200:203], v[104:107], v[160:163]
    ds_read_b64_tr_b16 v[198:199], v236 offset:37376
    s_add_u32 m0, s33, 0
    s_nop 0
    buffer_load_dwordx4 v239, s[12:15], s34 offen  lds
    s_add_u32 s34, s34, s36
    s_waitcnt lgkmcnt(8)
    v_mfma_f32_16x16x32_bf16 v[148:151], v[204:207], v[108:111], v[148:151]
    ds_read_b64_tr_b16 v[200:201], v237 offset:36864
    v_mfma_f32_16x16x32_bf16 v[156:159], v[204:207], v[112:115], v[156:159]
    ds_read_b64_tr_b16 v[202:203], v237 offset:37376
    v_cvt_pk_bf16_f32 v234, v176, v177
    v_cvt_pk_bf16_f32 v235, v178, v179
    s_waitcnt lgkmcnt(8)
    v_mfma_f32_16x16x32_bf16 v[152:155], v[208:211], v[108:111], v[152:155]
    ds_read_b64_tr_b16 v[204:205], v236 offset:40960
    v_mfma_f32_16x16x32_bf16 v[160:163], v[208:211], v[112:115], v[160:163]
    ds_read_b64_tr_b16 v[206:207], v236 offset:41472
    s_waitcnt lgkmcnt(8)
    v_mfma_f32_16x16x32_bf16 v[148:151], v[212:215], v[116:119], v[148:151]
    ds_read_b64_tr_b16 v[208:209], v237 offset:40960
    v_mfma_f32_16x16x32_bf16 v[156:159], v[212:215], v[120:123], v[156:159]
    ds_read_b64_tr_b16 v[210:211], v237 offset:41472
    s_add_u32 s42, s44, 65536
    buffer_store_dwordx2 v[234:235], v246, s[20:23], s42 offen offset:128 sc1
    s_waitcnt lgkmcnt(8)
    v_mfma_f32_16x16x32_bf16 v[152:155], v[216:219], v[116:119], v[152:155]
    ds_read_b64_tr_b16 v[212:213], v236 offset:45056
    v_mfma_f32_16x16x32_bf16 v[160:163], v[216:219], v[120:123], v[160:163]
    ds_read_b64_tr_b16 v[214:215], v236 offset:45568
    s_add_u32 m0, s33, 8192
    s_nop 0
    buffer_load_dwordx4 v239, s[12:15], s34 offen  lds
    s_add_u32 s34, s34, s36
    s_waitcnt lgkmcnt(8)
    v_mfma_f32_16x16x32_bf16 v[148:151], v[196:199], v[124:127], v[148:151]
    ds_read_b64_tr_b16 v[216:217], v237 offset:45056
    v_mfma_f32_16x16x32_bf16 v[156:159], v[196:199], v[128:131], v[156:159]
    ds_read_b64_tr_b16 v[218:219], v237 offset:45568
    s_waitcnt lgkmcnt(8)
    v_mfma_f32_16x16x32_bf16 v[152:155], v[200:203], v[124:127], v[152:155]
    v_add_u32 v236, 98304, v236
    v_add_u32 v237, 98304, v237
    ds_read_b64_tr_b16 v[196:197], v236 offset:0
    v_mfma_f32_16x16x32_bf16 v[160:163], v[200:203], v[128:131], v[160:163]
    ds_read_b64_tr_b16 v[198:199], v236 offset:512
    s_waitcnt lgkmcnt(8)
    v_mfma_f32_16x16x32_bf16 v[148:151], v[204:207], v[132:135], v[148:151]
    ds_read_b64_tr_b16 v[200:201], v237 offset:0
    v_mfma_f32_16x16x32_bf16 v[156:159], v[204:207], v[136:139], v[156:159]
    ds_read_b64_tr_b16 v[202:203], v237 offset:512
    s_waitcnt lgkmcnt(8)
    v_mfma_f32_16x16x32_bf16 v[152:155], v[208:211], v[132:135], v[152:155]
    ds_read_b64_tr_b16 v[204:205], v236 offset:4096
    v_mfma_f32_16x16x32_bf16 v[160:163], v[208:211], v[136:139], v[160:163]
    ds_read_b64_tr_b16 v[206:207], v236 offset:4608
    s_add_u32 m0, s33, 16384
    s_nop 0
    buffer_load_dwordx4 v239, s[12:15], s34 offen  lds
    s_add_u32 s34, s34, s36
    s_waitcnt lgkmcnt(8)
    v_mfma_f32_16x16x32_bf16 v[148:151], v[212:215], v[140:143], v[148:151]
    ds_read_b64_tr_b16 v[208:209], v237 offset:4096
    v_mfma_f32_16x16x32_bf16 v[156:159], v[212:215], v[144:147], v[156:159]
    ds_read_b64_tr_b16 v[210:211], v237 offset:4608
    s_waitcnt lgkmcnt(8)
    v_mfma_f32_16x16x32_bf16 v[152:155], v[216:219], v[140:143], v[152:155]
    ds_read_b64_tr_b16 v[212:213], v236 offset:8192
    v_mfma_f32_16x16x32_bf16 v[160:163], v[216:219], v[144:147], v[160:163]
    ds_read_b64_tr_b16 v[214:215], v236 offset:8704
    s_add_u32 s44, s44, 2097152
    s_waitcnt lgkmcnt(8)
    v_mfma_f32_16x16x32_bf16 v[164:167], v[4:7], v[196:199], 0
    s_waitcnt vmcnt(13)
    s_barrier
    ds_read_b64_tr_b16 v[216:217], v237 offset:8192
    v_mfma_f32_16x16x32_bf16 v[172:175], v[8:11], v[196:199], 0
    ds_read_b64_tr_b16 v[218:219], v237 offset:8704
    s_waitcnt lgkmcnt(8)
    v_mfma_f32_16x16x32_bf16 v[168:171], v[4:7], v[200:203], 0
    ds_read_b64_tr_b16 v[196:197], v236 offset:12288
    v_mfma_f32_16x16x32_bf16 v[176:179], v[8:11], v[200:203], 0
    ds_read_b64_tr_b16 v[198:199], v236 offset:12800
    s_add_u32 m0, s33, 24576
    s_nop 0
    buffer_load_dwordx4 v239, s[12:15], s34 offen  lds
    s_add_u32 s34, s34, s36
    s_waitcnt lgkmcnt(8)
    v_mfma_f32_16x16x32_bf16 v[164:167], v[12:15], v[204:207], v[164:167]
    ds_read_b64_tr_b16 v[200:201], v237 offset:12288
    v_mfma_f32_16x16x32_bf16 v[172:175], v[16:19], v[204:207], v[172:175]
    ds_read_b64_tr_b16 v[202:203], v237 offset:12800
    s_waitcnt lgkmcnt(8)
    v_mfma_f32_16x16x32_bf16 v[168:171], v[12:15], v[208:211], v[168:171]
    ds_read_b64_tr_b16 v[204:205], v236 offset:16384
    v_mfma_f32_16x16x32_bf16 v[176:179], v[16:19], v[208:211], v[176:179]
    ds_read_b64_tr_b16 v[206:207], v236 offset:16896
    v_cvt_pk_bf16_f32 v228, v148, v149
    v_cvt_pk_bf16_f32 v229, v150, v151
    s_waitcnt lgkmcnt(8)
    v_mfma_f32_16x16x32_bf16 v[164:167], v[20:23], v[212:215], v[164:167]
    ds_read_b64_tr_b16 v[208:209], v237 offset:16384
    v_mfma_f32_16x16x32_bf16 v[172:175], v[24:27], v[212:215], v[172:175]
    ds_read_b64_tr_b16 v[210:211], v237 offset:16896
    s_waitcnt lgkmcnt(8)
    v_mfma_f32_16x16x32_bf16 v[168:171], v[20:23], v[216:219], v[168:171]
    ds_read_b64_tr_b16 v[212:213], v236 offset:20480
    v_mfma_f32_16x16x32_bf16 v[176:179], v[24:27], v[216:219], v[176:179]
    ds_read_b64_tr_b16 v[214:215], v236 offset:20992
    s_add_u32 s42, s44, 0
    buffer_store_dwordx2 v[228:229], v246, s[20:23], s42 offen offset:0 sc1
    s_add_u32 m0, s33, 32768
    s_nop 0
    buffer_load_dwordx4 v239, s[12:15], s34 offen  lds
    s_add_u32 s34, s34, s36
    s_waitcnt lgkmcnt(8)
    v_mfma_f32_16x16x32_bf16 v[164:167], v[28:31], v[196:199], v[164:167]
    ds_read_b64_tr_b16 v[216:217], v237 offset:20480
    v_mfma_f32_16x16x32_bf16 v[172:175], v[32:35], v[196:199], v[172:175]
    ds_read_b64_tr_b16 v[218:219], v237 offset:20992
    s_waitcnt lgkmcnt(8)
    v_mfma_f32_16x16x32_bf16 v[168:171], v[28:31], v[200:203], v[168:171]
    ds_read_b64_tr_b16 v[196:197], v236 offset:24576
    v_mfma_f32_16x16x32_bf16 v[176:179], v[32:35], v[200:203], v[176:179]
    ds_read_b64_tr_b16 v[198:199], v236 offset:25088
    v_cvt_pk_bf16_f32 v230, v152, v153
    v_cvt_pk_bf16_f32 v231, v154, v155
    s_waitcnt lgkmcnt(8)
    v_mfma_f32_16x16x32_bf16 v[164:167], v[36:39], v[204:207], v[164:167]
    ds_read_b64_tr_b16 v[200:201], v237 offset:24576
    v_mfma_f32_16x16x32_bf16 v[172:175], v[40:43], v[204:207], v[172:175]
    ds_read_b64_tr_b16 v[202:203], v237 offset:25088
    s_waitcnt lgkmcnt(8)
    v_mfma_f32_16x16x32_bf16 v[168:171], v[36:39], v[208:211], v[168:171]
    ds_read_b64_tr_b16 v[204:205], v236 offset:28672
    v_mfma_f32_16x16x32_bf16 v[176:179], v[40:43], v[208:211], v[176:179]
    ds_read_b64_tr_b16 v[206:207], v236 offset:29184
    s_add_u32 s42, s44, 65536
    buffer_store_dwordx2 v[230:231], v246, s[20:23], s42 offen offset:0 sc1
    s_add_u32 m0, s33, 40960
    s_nop 0
    buffer_load_dwordx4 v239, s[12:15], s34 offen  lds
    s_add_u32 s34, s34, s36
    s_waitcnt lgkmcnt(8)
    v_mfma_f32_16x16x32_bf16 v[164:167], v[44:47], v[212:215], v[164:167]
    ds_read_b64_tr_b16 v[208:209], v237 offset:28672
    v_mfma_f32_16x16x32_bf16 v[172:175], v[48:51], v[212:215], v[172:175]
    ds_read_b64_tr_b16 v[210:211], v237 offset:29184
    s_waitcnt lgkmcnt(8)
    v_mfma_f32_16x16x32_bf16 v[168:171], v[44:47], v[216:219], v[168:171]
    ds_read_b64_tr_b16 v[212:213], v236 offset:32768
    v_mfma_f32_16x16x32_bf16 v[176:179], v[48:51], v[216:219], v[176:179]
    ds_read_b64_tr_b16 v[214:215], v236 offset:33280
    v_cvt_pk_bf16_f32 v232, v156, v157
    v_cvt_pk_bf16_f32 v233, v158, v159
    s_waitcnt lgkmcnt(8)
    v_mfma_f32_16x16x32_bf16 v[164:167], v[52:55], v[196:199], v[164:167]
    s_waitcnt vmcnt(14)
    s_barrier
    ds_read_b64_tr_b16 v[216:217], v237 offset:32768
    v_mfma_f32_16x16x32_bf16 v[172:175], v[56:59], v[196:199], v[172:175]
    ds_read_b64_tr_b16 v[218:219], v237 offset:33280
    s_mov_b32 s16, s54
    s_mov_b32 s17, s55
    s_mov_b32 s18, 5308416
    s_mov_b32 s35, s40
    s_mov_b32 s37, 589824
    v_mov_b32 v240, v239
    s_waitcnt lgkmcnt(8)
    v_mfma_f32_16x16x32_bf16 v[168:171], v[52:55], v[200:203], v[168:171]
    ds_read_b64_tr_b16 v[196:197], v236 offset:36864
    v_mfma_f32_16x16x32_bf16 v[176:179], v[56:59], v[200:203], v[176:179]
    ds_read_b64_tr_b16 v[198:199], v236 offset:37376
    s_add_u32 s42, s44, 0
    buffer_store_dwordx2 v[232:233], v246, s[20:23], s42 offen offset:128 sc1
    s_add_u32 m0, s33, 98304
    s_nop 0
    buffer_load_dwordx4 v240, s[16:19], s35 offen  lds
    s_add_u32 s35, s35, s37
    s_waitcnt lgkmcnt(8)
    v_mfma_f32_16x16x32_bf16 v[164:167], v[60:63], v[204:207], v[164:167]
    ds_read_b64_tr_b16 v[200:201], v237 offset:36864
    v_mfma_f32_16x16x32_bf16 v[172:175], v[64:67], v[204:207], v[172:175]
    ds_read_b64_tr_b16 v[202:203], v237 offset:37376
    s_waitcnt lgkmcnt(8)
    v_mfma_f32_16x16x32_bf16 v[168:171], v[60:63], v[208:211], v[168:171]
    ds_read_b64_tr_b16 v[204:205], v236 offset:40960
    v_mfma_f32_16x16x32_bf16 v[176:179], v[64:67], v[208:211], v[176:179]
    ds_read_b64_tr_b16 v[206:207], v236 offset:41472
    v_cvt_pk_bf16_f32 v234, v160, v161
    v_cvt_pk_bf16_f32 v235, v162, v163
    s_waitcnt lgkmcnt(8)
    v_mfma_f32_16x16x32_bf16 v[164:167], v[68:71], v[212:215], v[164:167]
    ds_read_b64_tr_b16 v[208:209], v237 offset:40960
    v_mfma_f32_16x16x32_bf16 v[172:175], v[72:75], v[212:215], v[172:175]
    ds_read_b64_tr_b16 v[210:211], v237 offset:41472
    s_waitcnt lgkmcnt(8)
    v_mfma_f32_16x16x32_bf16 v[168:171], v[68:71], v[216:219], v[168:171]
    ds_read_b64_tr_b16 v[212:213], v236 offset:45056
    v_mfma_f32_16x16x32_bf16 v[176:179], v[72:75], v[216:219], v[176:179]
    ds_read_b64_tr_b16 v[214:215], v236 offset:45568
    s_add_u32 s42, s44, 65536
    buffer_store_dwordx2 v[234:235], v246, s[20:23], s42 offen offset:128 sc1
    s_add_u32 m0, s33, 106496
    s_nop 0
    buffer_load_dwordx4 v240, s[16:19], s35 offen  lds
    s_add_u32 s35, s35, s37
    s_waitcnt lgkmcnt(8)
    v_mfma_f32_16x16x32_bf16 v[164:167], v[76:79], v[196:199], v[164:167]
    ds_read_b64_tr_b16 v[216:217], v237 offset:45056
    v_mfma_f32_16x16x32_bf16 v[172:175], v[80:83], v[196:199], v[172:175]
    ds_read_b64_tr_b16 v[218:219], v237 offset:45568
    s_waitcnt lgkmcnt(8)
    v_mfma_f32_16x16x32_bf16 v[168:171], v[76:79], v[200:203], v[168:171]
    v_add_u32 v236, 4294918144, v236
    v_add_u32 v237, 4294918144, v237
    ds_read_b64_tr_b16 v[196:197], v236 offset:0
    v_mfma_f32_16x16x32_bf16 v[176:179], v[80:83], v[200:203], v[176:179]
    ds_read_b64_tr_b16 v[198:199], v236 offset:512
    s_waitcnt lgkmcnt(8)
    v_mfma_f32_16x16x32_bf16 v[164:167], v[84:87], v[204:207], v[164:167]
    ds_read_b64_tr_b16 v[200:201], v237 offset:0
    v_mfma_f32_16x16x32_bf16 v[172:175], v[88:91], v[204:207], v[172:175]
    ds_read_b64_tr_b16 v[202:203], v237 offset:512
    s_waitcnt lgkmcnt(8)
    v_mfma_f32_16x16x32_bf16 v[168:171], v[84:87], v[208:211], v[168:171]
    ds_read_b64_tr_b16 v[204:205], v236 offset:4096
    v_mfma_f32_16x16x32_bf16 v[176:179], v[88:91], v[208:211], v[176:179]
    ds_read_b64_tr_b16 v[206:207], v236 offset:4608
    s_add_u32 m0, s33, 114688
    s_nop 0
    buffer_load_dwordx4 v240, s[16:19], s35 offen  lds
    s_add_u32 s35, s35, s37
    s_waitcnt lgkmcnt(8)
    v_mfma_f32_16x16x32_bf16 v[164:167], v[92:95], v[212:215], v[164:167]
    ds_read_b64_tr_b16 v[208:209], v237 offset:4096
    v_mfma_f32_16x16x32_bf16 v[172:175], v[96:99], v[212:215], v[172:175]
    ds_read_b64_tr_b16 v[210:211], v237 offset:4608
    s_waitcnt lgkmcnt(8)
    v_mfma_f32_16x16x32_bf16 v[168:171], v[92:95], v[216:219], v[168:171]
    ds_read_b64_tr_b16 v[212:213], v236 offset:8192
    v_mfma_f32_16x16x32_bf16 v[176:179], v[96:99], v[216:219], v[176:179]
    ds_read_b64_tr_b16 v[214:215], v236 offset:8704
    s_waitcnt lgkmcnt(8)
    v_mfma_f32_16x16x32_bf16 v[164:167], v[100:103], v[196:199], v[164:167]
    s_waitcnt vmcnt(14)
    s_barrier
    ds_read_b64_tr_b16 v[216:217], v237 offset:8192
    v_mfma_f32_16x16x32_bf16 v[172:175], v[104:107], v[196:199], v[172:175]
    ds_read_b64_tr_b16 v[218:219], v237 offset:8704
    s_waitcnt lgkmcnt(8)
    v_mfma_f32_16x16x32_bf16 v[168:171], v[100:103], v[200:203], v[168:171]
    ds_read_b64_tr_b16 v[196:197], v236 offset:12288
    v_mfma_f32_16x16x32_bf16 v[176:179], v[104:107], v[200:203], v[176:179]
    ds_read_b64_tr_b16 v[198:199], v236 offset:12800
    s_add_u32 m0, s33, 122880
    s_nop 0
    buffer_load_dwordx4 v240, s[16:19], s35 offen  lds
    s_add_u32 s35, s35, s37
    s_waitcnt lgkmcnt(8)
    v_mfma_f32_16x16x32_bf16 v[164:167], v[108:111], v[204:207], v[164:167]
    ds_read_b64_tr_b16 v[200:201], v237 offset:12288
    v_mfma_f32_16x16x32_bf16 v[172:175], v[112:115], v[204:207], v[172:175]
    ds_read_b64_tr_b16 v[202:203], v237 offset:12800
    s_waitcnt lgkmcnt(8)
    v_mfma_f32_16x16x32_bf16 v[168:171], v[108:111], v[208:211], v[168:171]
    ds_read_b64_tr_b16 v[204:205], v236 offset:16384
    v_mfma_f32_16x16x32_bf16 v[176:179], v[112:115], v[208:211], v[176:179]
    ds_read_b64_tr_b16 v[206:207], v236 offset:16896
    s_waitcnt lgkmcnt(8)
    v_mfma_f32_16x16x32_bf16 v[164:167], v[116:119], v[212:215], v[164:167]
    ds_read_b64_tr_b16 v[208:209], v237 offset:16384
    v_mfma_f32_16x16x32_bf16 v[172:175], v[120:123], v[212:215], v[172:175]
    ds_read_b64_tr_b16 v[210:211], v237 offset:16896
    s_waitcnt lgkmcnt(8)
    v_mfma_f32_16x16x32_bf16 v[168:171], v[116:119], v[216:219], v[168:171]
    ds_read_b64_tr_b16 v[212:213], v236 offset:20480
    v_mfma_f32_16x16x32_bf16 v[176:179], v[120:123], v[216:219], v[176:179]
    ds_read_b64_tr_b16 v[214:215], v236 offset:20992
    s_add_u32 m0, s33, 131072
    s_nop 0
    buffer_load_dwordx4 v240, s[16:19], s35 offen  lds
    s_add_u32 s35, s35, s37
    s_waitcnt lgkmcnt(8)
    v_mfma_f32_16x16x32_bf16 v[164:167], v[124:127], v[196:199], v[164:167]
    ds_read_b64_tr_b16 v[216:217], v237 offset:20480
    v_mfma_f32_16x16x32_bf16 v[172:175], v[128:131], v[196:199], v[172:175]
    ds_read_b64_tr_b16 v[218:219], v237 offset:20992
    s_waitcnt lgkmcnt(8)
    v_mfma_f32_16x16x32_bf16 v[168:171], v[124:127], v[200:203], v[168:171]
    ds_read_b64_tr_b16 v[196:197], v236 offset:24576
    v_mfma_f32_16x16x32_bf16 v[176:179], v[128:131], v[200:203], v[176:179]
    ds_read_b64_tr_b16 v[198:199], v236 offset:25088
    s_waitcnt lgkmcnt(8)
    v_mfma_f32_16x16x32_bf16 v[164:167], v[132:135], v[204:207], v[164:167]
    ds_read_b64_tr_b16 v[200:201], v237 offset:24576
    v_mfma_f32_16x16x32_bf16 v[172:175], v[136:139], v[204:207], v[172:175]
    ds_read_b64_tr_b16 v[202:203], v237 offset:25088
    s_waitcnt lgkmcnt(8)
    v_mfma_f32_16x16x32_bf16 v[168:171], v[132:135], v[208:211], v[168:171]
    ds_read_b64_tr_b16 v[204:205], v236 offset:28672
    v_mfma_f32_16x16x32_bf16 v[176:179], v[136:139], v[208:211], v[176:179]
    ds_read_b64_tr_b16 v[206:207], v236 offset:29184
    s_add_u32 m0, s33, 139264
    s_nop 0
    buffer_load_dwordx4 v240, s[16:19], s35 offen  lds
    s_add_u32 s35, s35, s37
    s_waitcnt lgkmcnt(8)
    v_mfma_f32_16x16x32_bf16 v[164:167], v[140:143], v[212:215], v[164:167]
    ds_read_b64_tr_b16 v[208:209], v237 offset:28672
    v_mfma_f32_16x16x32_bf16 v[172:175], v[144:147], v[212:215], v[172:175]
    ds_read_b64_tr_b16 v[210:211], v237 offset:29184
    s_waitcnt lgkmcnt(8)
    v_mfma_f32_16x16x32_bf16 v[168:171], v[140:143], v[216:219], v[168:171]
    ds_read_b64_tr_b16 v[212:213], v236 offset:32768
    v_mfma_f32_16x16x32_bf16 v[176:179], v[144:147], v[216:219], v[176:179]
    ds_read_b64_tr_b16 v[214:215], v236 offset:33280
    s_mov_b32 s41, s63
    s_lshl_b32 s41, s41, 6
    s_lshl_b32 s42, s29, 5
    s_add_u32 s41, s41, s42
    v_and_b32 v224, 15, v0
    v_add_u32 v224, s41, v224
    v_lshrrev_b32 v227, 4, v0
    v_mul_u32_u24 v227, 288, v227
    s_mul_i32 s41, s47, 1152
    s_add_u32 s41, s41, 4718592
    v_mul_u32_u24 v225, 3641, v224
    v_lshrrev_b32 v225, 16, v225
    v_mul_u32_u24 v226, 18, v225
    v_sub_u32 v226, v224, v226
    v_mul_u32_u24 v225, 73728, v225
    v_lshl_add_u32 v225, v226, 4, v225
    v_add_u32 v225, v225, v227
    v_add_u32 v224, 16, v224
    v_cvt_pk_bf16_f32 v228, v164, v165
    v_cvt_pk_bf16_f32 v229, v166, v167
    v_cvt_pk_bf16_f32 v230, v172, v173
    v_cvt_pk_bf16_f32 v231, v174, v175
    s_nop 0
    v_permlane32_swap_b32 v228, v230
    v_permlane32_swap_b32 v229, v231
    buffer_store_dwordx4 v[228:231], v225, s[20:23], s41 offen sc1
    v_mul_u32_u24 v225, 3641, v224
    v_lshrrev_b32 v225, 16, v225
    v_mul_u32_u24 v226, 18, v225
    v_sub_u32 v226, v224, v226
    v_mul_u32_u24 v225, 73728, v225
    v_lshl_add_u32 v225, v226, 4, v225
    v_add_u32 v225, v225, v227
    v_add_u32 v224, 16, v224
    v_cvt_pk_bf16_f32 v232, v168, v169
    v_cvt_pk_bf16_f32 v233, v170, v171
    v_cvt_pk_bf16_f32 v234, v176, v177
    v_cvt_pk_bf16_f32 v235, v178, v179
    s_nop 0
    v_permlane32_swap_b32 v232, v234
    v_permlane32_swap_b32 v233, v235
    buffer_store_dwordx4 v[232:235], v225, s[20:23], s41 offen sc1
    s_branch K1_PRE
K1_BT:
    s_lshl_b32 s41, s29, 11
    s_add_u32 s92, s92, s41
    s_lshr_b32 s41, s30, 1
    s_mul_i32 s41, s41, 36864
    s_add_u32 s92, s92, s41
    s_and_b32 s41, s30, 1
    s_lshl_b32 s41, s41, 10
    s_add_u32 s92, s92, s41
    s_add_u32 s92, s92, 29360128
    s_cmp_eq_u32 s91, 3
    s_cselect_b32 s92, 0x7ff00000, s92
    s_waitcnt vmcnt(3)
    s_barrier
    v_add_u32 v236, 4294918144, v236
    v_add_u32 v237, 4294918144, v237
    v_add_u32 v236, 98304, v236
    v_add_u32 v237, 98304, v237
    s_waitcnt lgkmcnt(9)
    ds_read_b64_tr_b16 v[196:197], v236 offset:0
    s_waitcnt lgkmcnt(9)
    ds_read_b64_tr_b16 v[198:199], v236 offset:512
    s_waitcnt lgkmcnt(9)
    ds_read_b64_tr_b16 v[200:201], v237 offset:0
    s_waitcnt lgkmcnt(9)
    ds_read_b64_tr_b16 v[202:203], v237 offset:512
    s_waitcnt lgkmcnt(9)
    ds_read_b64_tr_b16 v[204:205], v236 offset:4096
    s_waitcnt lgkmcnt(9)
    ds_read_b64_tr_b16 v[206:207], v236 offset:4608
    s_waitcnt lgkmcnt(9)
    ds_read_b64_tr_b16 v[208:209], v237 offset:4096
    s_waitcnt lgkmcnt(9)
    ds_read_b64_tr_b16 v[210:211], v237 offset:4608
    s_waitcnt lgkmcnt(9)
    ds_read_b64_tr_b16 v[212:213], v236 offset:8192
    s_waitcnt lgkmcnt(9)
    ds_read_b64_tr_b16 v[214:215], v236 offset:8704
    s_add_u32 m0, s33, 49152
    s_nop 0
    buffer_load_dwordx4 v240, s[16:19], s35 offen  lds
    s_add_u32 s35, s35, s37
    s_add_u32 m0, s33, 57344
    s_nop 0
    buffer_load_dwordx4 v240, s[16:19], s35 offen  lds
    s_add_u32 s35, s35, s37
    s_add_u32 m0, s33, 65536
    s_nop 0
    buffer_load_dwordx4 v240, s[16:19], s35 offen  lds
    s_add_u32 s35, s35, s37
    v_cvt_pk_bf16_f32 v164, v164, v165
    v_cvt_pk_bf16_f32 v165, v166, v167
    s_add_u32 s42, s44, 0
    buffer_store_dwordx2 v[164:165], v246, s[20:23], s42 offen offset:0 sc1
    v_cvt_pk_bf16_f32 v168, v168, v169
    v_cvt_pk_bf16_f32 v169, v170, v171
    s_add_u32 s42, s44, 65536
    buffer_store_dwordx2 v[168:169], v246, s[20:23], s42 offen offset:0 sc1
    v_cvt_pk_bf16_f32 v172, v172, v173
    v_cvt_pk_bf16_f32 v173, v174, v175
    s_add_u32 s42, s44, 0
    buffer_store_dwordx2 v[172:173], v246, s[20:23], s42 offen offset:128 sc1
    v_cvt_pk_bf16_f32 v176, v176, v177
    v_cvt_pk_bf16_f32 v177, v178, v179
    s_add_u32 s42, s44, 65536
    buffer_store_dwordx2 v[176:177], v246, s[20:23], s42 offen offset:128 sc1
    s_mov_b32 s12, s52
    s_mov_b32 s13, s53
    s_mov_b32 s14, 5308416
    s_mov_b32 s34, s40
    s_mov_b32 s36, 589824
    v_mul_u32_u24 v239, 9216, v241
    v_add_u32 v239, v239, v242
    s_add_u32 m0, s33, 73728
    s_nop 0
    buffer_load_dwordx4 v239, s[12:15], s34 offen  lds
    s_add_u32 s34, s34, s36
    s_add_u32 m0, s33, 81920
    s_nop 0
    buffer_load_dwordx4 v239, s[12:15], s34 offen  lds
    s_add_u32 s34, s34, s36
    s_add_u32 m0, s33, 90112
    s_nop 0
    buffer_load_dwordx4 v239, s[12:15], s34 offen  lds
    s_add_u32 s34, s34, s36
    s_waitcnt lgkmcnt(8)
    v_mfma_f32_16x16x32_bf16 v[164:167], v[4:7], v[196:199], 0
    s_waitcnt vmcnt(10)
    s_barrier
    ds_read_b64_tr_b16 v[216:217], v237 offset:8192
    v_mfma_f32_16x16x32_bf16 v[172:175], v[8:11], v[196:199], 0
    ds_read_b64_tr_b16 v[218:219], v237 offset:8704
    s_add_u32 m0, s33, 0
    s_nop 0
    buffer_load_dwordx4 v239, s[12:15], s34 offen  lds
    s_add_u32 s34, s34, s36
    s_add_u32 m0, s33, 8192
    s_nop 0
    buffer_load_dwordx4 v239, s[12:15], s34 offen  lds
    s_add_u32 s34, s34, s36
    s_add_u32 m0, s33, 16384
    s_nop 0
    buffer_load_dwordx4 v239, s[12:15], s34 offen  lds
    s_add_u32 s34, s34, s36
    s_waitcnt lgkmcnt(8)
    v_mfma_f32_16x16x32_bf16 v[168:171], v[4:7], v[200:203], 0
    ds_read_b64_tr_b16 v[196:197], v236 offset:12288
    v_mfma_f32_16x16x32_bf16 v[176:179], v[8:11], v[200:203], 0
    ds_read_b64_tr_b16 v[198:199], v236 offset:12800
    s_add_u32 m0, s33, 24576
    s_nop 0
    buffer_load_dwordx4 v239, s[12:15], s34 offen  lds
    s_add_u32 s34, s34, s36
    s_waitcnt lgkmcnt(8)
    v_mfma_f32_16x16x32_bf16 v[164:167], v[12:15], v[204:207], v[164:167]
    ds_read_b64_tr_b16 v[200:201], v237 offset:12288
    v_mfma_f32_16x16x32_bf16 v[172:175], v[16:19], v[204:207], v[172:175]
    ds_read_b64_tr_b16 v[202:203], v237 offset:12800
    s_lshl_b32 s85, s84, 3
    s_add_u32 s85, s85, s28
    v_lshrrev_b32 v223, 2, v0
    v_bfe_u32 v220, v0, 4, 1
    v_lshlrev_b32 v220, 3, v220
    v_lshrrev_b32 v221, 5, v0
    v_lshl_add_u32 v220, v221, 2, v220
    v_bfe_u32 v221, v0, 2, 2
    v_add_u32 v220, v220, v221
    v_lshrrev_b32 v221, 1, v223
    v_mul_u32_u24 v221, 18, v221
    v_and_b32 v222, 1, v223
    v_add3_u32 v221, v221, v222, 16
    v_and_b32 v222, 3, v0
    s_waitcnt lgkmcnt(8)
    v_mfma_f32_16x16x32_bf16 v[168:171], v[12:15], v[208:211], v[168:171]
    ds_read_b64_tr_b16 v[204:205], v236 offset:16384
    v_mfma_f32_16x16x32_bf16 v[176:179], v[16:19], v[208:211], v[176:179]
    ds_read_b64_tr_b16 v[206:207], v236 offset:16896
    v_lshlrev_b32 v222, 4, v222
    v_mul_u32_u24 v220, 1152, v220
    v_add_u32 v220, v220, v222
    v_mul_u32_u24 v221, 1152, v221
    v_add_u32 v221, v221, v222
    v_lshrrev_b32 v222, 5, v0
    v_lshlrev_b32 v222, 9, v222
    v_bfe_u32 v223, v0, 2, 2
    v_lshl_add_u32 v222, v223, 6, v222
    v_and_b32 v223, 3, v0
    v_lshl_add_u32 v222, v223, 4, v222
    v_bfe_u32 v223, v0, 4, 1
    v_lshl_add_u32 v222, v223, 3, v222
    s_lshl_b32 s61, s28, 11
    s_waitcnt lgkmcnt(8)
    v_mfma_f32_16x16x32_bf16 v[164:167], v[20:23], v[212:215], v[164:167]
    ds_read_b64_tr_b16 v[208:209], v237 offset:16384
    v_mfma_f32_16x16x32_bf16 v[172:175], v[24:27], v[212:215], v[172:175]
    ds_read_b64_tr_b16 v[210:211], v237 offset:16896
    s_add_u32 s61, s61, 147456
    v_add_u32 v222, s61, v222
    s_mov_b32 s8, s94
    s_mov_b32 s9, s95
    s_mov_b32 s10, 663552
    s_mov_b32 s11, 0x20000
    s_waitcnt lgkmcnt(8)
    v_mfma_f32_16x16x32_bf16 v[168:171], v[20:23], v[216:219], v[168:171]
    ds_read_b64_tr_b16 v[212:213], v236 offset:20480
    v_mfma_f32_16x16x32_bf16 v[176:179], v[24:27], v[216:219], v[176:179]
    ds_read_b64_tr_b16 v[214:215], v236 offset:20992
    s_add_u32 m0, s33, 32768
    s_nop 0
    buffer_load_dwordx4 v239, s[12:15], s34 offen  lds
    s_add_u32 s34, s34, s36
    s_waitcnt lgkmcnt(8)
    v_mfma_f32_16x16x32_bf16 v[164:167], v[28:31], v[196:199], v[164:167]
    ds_read_b64_tr_b16 v[216:217], v237 offset:20480
    v_mfma_f32_16x16x32_bf16 v[172:175], v[32:35], v[196:199], v[172:175]
    ds_read_b64_tr_b16 v[218:219], v237 offset:20992
    s_mul_i32 s60, s85, 3641
    s_lshr_b32 s60, s60, 16
    s_mul_i32 s41, s60, 18
    s_sub_u32 s42, s85, s41
    s_lshl_b32 s42, s42, 6
    s_mul_i32 s41, s41, 1152
    s_sub_u32 s3, s60, 32
    s_mul_i32 s3, s3, 165888
    s_cmp_ge_u32 s60, 32
    s_cselect_b32 s41, s3, s41
    s_cselect_b64 vcc, -1, 0
    v_cndmask_b32 v223, v220, v221, vcc
    s_add_u32 s41, s41, s42
    s_lshl_b32 s42, s42, 5
    s_lshr_b32 s3, s60, 1
    s_mul_i32 s3, s3, 36864
    s_add_u32 s42, s42, s3
    s_and_b32 s3, s60, 1
    s_lshl_b32 s3, s3, 9
    s_add_u32 s42, s42, s3
    s_add_u32 s86, s42, 40894464
    s_add_u32 m0, s61, 0
    s_nop 0
    buffer_load_dwordx4 v223, s[8:11], s41 offen lds
    s_waitcnt lgkmcnt(8)
    v_mfma_f32_16x16x32_bf16 v[168:171], v[28:31], v[200:203], v[168:171]
    ds_read_b64_tr_b16 v[196:197], v236 offset:24576
    v_mfma_f32_16x16x32_bf16 v[176:179], v[32:35], v[200:203], v[176:179]
    ds_read_b64_tr_b16 v[198:199], v236 offset:25088
    s_add_u32 s85, s85, 640
    s_min_u32 s85, s85, 700
    s_mul_i32 s60, s85, 3641
    s_lshr_b32 s60, s60, 16
    s_mul_i32 s41, s60, 18
    s_sub_u32 s42, s85, s41
    s_lshl_b32 s42, s42, 6
    s_mul_i32 s41, s41, 1152
    s_sub_u32 s3, s60, 32
    s_mul_i32 s3, s3, 165888
    s_cmp_ge_u32 s60, 32
    s_cselect_b32 s41, s3, s41
    s_cselect_b64 vcc, -1, 0
    v_cndmask_b32 v223, v220, v221, vcc
    s_add_u32 s41, s41, s42
    s_lshl_b32 s42, s42, 5
    s_lshr_b32 s3, s60, 1
    s_mul_i32 s3, s3, 36864
    s_add_u32 s42, s42, s3
    s_and_b32 s3, s60, 1
    s_lshl_b32 s3, s3, 9
    s_add_u32 s42, s42, s3
    s_add_u32 s87, s42, 40894464
    s_add_u32 m0, s61, 1024
    s_nop 0
    buffer_load_dwordx4 v223, s[8:11], s41 offen lds
    s_waitcnt lgkmcnt(8)
    v_mfma_f32_16x16x32_bf16 v[164:167], v[36:39], v[204:207], v[164:167]
    ds_read_b64_tr_b16 v[200:201], v237 offset:24576
    v_mfma_f32_16x16x32_bf16 v[172:175], v[40:43], v[204:207], v[172:175]
    ds_read_b64_tr_b16 v[202:203], v237 offset:25088
    s_waitcnt lgkmcnt(8)
    v_mfma_f32_16x16x32_bf16 v[168:171], v[36:39], v[208:211], v[168:171]
    ds_read_b64_tr_b16 v[204:205], v236 offset:28672
    v_mfma_f32_16x16x32_bf16 v[176:179], v[40:43], v[208:211], v[176:179]
    ds_read_b64_tr_b16 v[206:207], v236 offset:29184
    s_add_u32 m0, s33, 40960
    s_nop 0
    buffer_load_dwordx4 v239, s[12:15], s34 offen  lds
    s_add_u32 s34, s34, s36
    s_waitcnt lgkmcnt(8)
    v_mfma_f32_16x16x32_bf16 v[164:167], v[44:47], v[212:215], v[164:167]
    ds_read_b64_tr_b16 v[208:209], v237 offset:28672
    v_mfma_f32_16x16x32_bf16 v[172:175], v[48:51], v[212:215], v[172:175]
    ds_read_b64_tr_b16 v[210:211], v237 offset:29184
    s_waitcnt lgkmcnt(8)
    v_mfma_f32_16x16x32_bf16 v[168:171], v[44:47], v[216:219], v[168:171]
    ds_read_b64_tr_b16 v[212:213], v236 offset:32768
    v_mfma_f32_16x16x32_bf16 v[176:179], v[48:51], v[216:219], v[176:179]
    ds_read_b64_tr_b16 v[214:215], v236 offset:33280
    s_waitcnt lgkmcnt(8)
    v_mfma_f32_16x16x32_bf16 v[164:167], v[52:55], v[196:199], v[164:167]
    s_waitcnt vmcnt(15)
    s_barrier
    ds_read_b64_tr_b16 v[216:217], v237 offset:32768
    v_mfma_f32_16x16x32_bf16 v[172:175], v[56:59], v[196:199], v[172:175]
    ds_read_b64_tr_b16 v[218:219], v237 offset:33280
    s_mov_b32 s16, s54
    s_mov_b32 s17, s55
    s_mov_b32 s18, 5308416
    s_mov_b32 s35, s40
    s_mov_b32 s37, 589824
    v_mov_b32 v240, v239
    s_waitcnt lgkmcnt(8)
    v_mfma_f32_16x16x32_bf16 v[168:171], v[52:55], v[200:203], v[168:171]
    ds_read_b64_tr_b16 v[196:197], v236 offset:36864
    v_mfma_f32_16x16x32_bf16 v[176:179], v[56:59], v[200:203], v[176:179]
    ds_read_b64_tr_b16 v[198:199], v236 offset:37376
    s_add_u32 m0, s33, 98304
    s_nop 0
    buffer_load_dwordx4 v240, s[16:19], s35 offen  lds
    s_add_u32 s35, s35, s37
    s_waitcnt lgkmcnt(8)
    v_mfma_f32_16x16x32_bf16 v[164:167], v[60:63], v[204:207], v[164:167]
    ds_read_b64_tr_b16 v[200:201], v237 offset:36864
    v_mfma_f32_16x16x32_bf16 v[172:175], v[64:67], v[204:207], v[172:175]
    ds_read_b64_tr_b16 v[202:203], v237 offset:37376
    s_waitcnt lgkmcnt(8)
    v_mfma_f32_16x16x32_bf16 v[168:171], v[60:63], v[208:211], v[168:171]
    ds_read_b64_tr_b16 v[204:205], v236 offset:40960
    v_mfma_f32_16x16x32_bf16 v[176:179], v[64:67], v[208:211], v[176:179]
    ds_read_b64_tr_b16 v[206:207], v236 offset:41472
    s_waitcnt lgkmcnt(8)
    v_mfma_f32_16x16x32_bf16 v[164:167], v[68:71], v[212:215], v[164:167]
    ds_read_b64_tr_b16 v[208:209], v237 offset:40960
    v_mfma_f32_16x16x32_bf16 v[172:175], v[72:75], v[212:215], v[172:175]
    ds_read_b64_tr_b16 v[210:211], v237 offset:41472
    s_waitcnt lgkmcnt(8)
    v_mfma_f32_16x16x32_bf16 v[168:171], v[68:71], v[216:219], v[168:171]
    ds_read_b64_tr_b16 v[212:213], v236 offset:45056
    v_mfma_f32_16x16x32_bf16 v[176:179], v[72:75], v[216:219], v[176:179]
    ds_read_b64_tr_b16 v[214:215], v236 offset:45568
    s_add_u32 m0, s33, 106496
    s_nop 0
    buffer_load_dwordx4 v240, s[16:19], s35 offen  lds
    s_add_u32 s35, s35, s37
    s_waitcnt lgkmcnt(8)
    v_mfma_f32_16x16x32_bf16 v[164:167], v[76:79], v[196:199], v[164:167]
    ds_read_b64_tr_b16 v[216:217], v237 offset:45056
    v_mfma_f32_16x16x32_bf16 v[172:175], v[80:83], v[196:199], v[172:175]
    ds_read_b64_tr_b16 v[218:219], v237 offset:45568
    s_waitcnt lgkmcnt(8)
    v_mfma_f32_16x16x32_bf16 v[168:171], v[76:79], v[200:203], v[168:171]
    v_add_u32 v236, 4294918144, v236
    v_add_u32 v237, 4294918144, v237
    ds_read_b64_tr_b16 v[196:197], v236 offset:0
    v_mfma_f32_16x16x32_bf16 v[176:179], v[80:83], v[200:203], v[176:179]
    ds_read_b64_tr_b16 v[198:199], v236 offset:512
    s_waitcnt lgkmcnt(8)
    v_mfma_f32_16x16x32_bf16 v[164:167], v[84:87], v[204:207], v[164:167]
    ds_read_b64_tr_b16 v[200:201], v237 offset:0
    v_mfma_f32_16x16x32_bf16 v[172:175], v[88:91], v[204:207], v[172:175]
    ds_read_b64_tr_b16 v[202:203], v237 offset:512
    s_waitcnt lgkmcnt(8)
    v_mfma_f32_16x16x32_bf16 v[168:171], v[84:87], v[208:211], v[168:171]
    ds_read_b64_tr_b16 v[204:205], v236 offset:4096
    v_mfma_f32_16x16x32_bf16 v[176:179], v[88:91], v[208:211], v[176:179]
    ds_read_b64_tr_b16 v[206:207], v236 offset:4608
    s_add_u32 m0, s33, 114688
    s_nop 0
    buffer_load_dwordx4 v240, s[16:19], s35 offen  lds
    s_add_u32 s35, s35, s37
    s_waitcnt lgkmcnt(8)
    v_mfma_f32_16x16x32_bf16 v[164:167], v[92:95], v[212:215], v[164:167]
    ds_read_b64_tr_b16 v[208:209], v237 offset:4096
    v_mfma_f32_16x16x32_bf16 v[172:175], v[96:99], v[212:215], v[172:175]
    ds_read_b64_tr_b16 v[210:211], v237 offset:4608
    s_waitcnt lgkmcnt(8)
    v_mfma_f32_16x16x32_bf16 v[168:171], v[92:95], v[216:219], v[168:171]
    ds_read_b64_tr_b16 v[212:213], v236 offset:8192
    v_mfma_f32_16x16x32_bf16 v[176:179], v[96:99], v[216:219], v[176:179]
    ds_read_b64_tr_b16 v[214:215], v236 offset:8704
    s_waitcnt lgkmcnt(8)
    v_mfma_f32_16x16x32_bf16 v[164:167], v[100:103], v[196:199], v[164:167]
    s_waitcnt vmcnt(11)
    s_barrier
    ds_read_b64_tr_b16 v[216:217], v237 offset:8192
    v_mfma_f32_16x16x32_bf16 v[172:175], v[104:107], v[196:199], v[172:175]
    ds_read_b64_tr_b16 v[218:219], v237 offset:8704
    s_waitcnt lgkmcnt(8)
    v_mfma_f32_16x16x32_bf16 v[168:171], v[100:103], v[200:203], v[168:171]
    ds_read_b64_tr_b16 v[196:197], v236 offset:12288
    v_mfma_f32_16x16x32_bf16 v[176:179], v[104:107], v[200:203], v[176:179]
    ds_read_b64_tr_b16 v[198:199], v236 offset:12800
    s_add_u32 m0, s33, 122880
    s_nop 0
    buffer_load_dwordx4 v240, s[16:19], s35 offen  lds
    s_add_u32 s35, s35, s37
    s_waitcnt lgkmcnt(8)
    v_mfma_f32_16x16x32_bf16 v[164:167], v[108:111], v[204:207], v[164:167]
    ds_read_b64_tr_b16 v[200:201], v237 offset:12288
    v_mfma_f32_16x16x32_bf16 v[172:175], v[112:115], v[204:207], v[172:175]
    ds_read_b64_tr_b16 v[202:203], v237 offset:12800
    s_waitcnt lgkmcnt(8)
    v_mfma_f32_16x16x32_bf16 v[168:171], v[108:111], v[208:211], v[168:171]
    ds_read_b64_tr_b16 v[204:205], v236 offset:16384
    v_mfma_f32_16x16x32_bf16 v[176:179], v[112:115], v[208:211], v[176:179]
    ds_read_b64_tr_b16 v[206:207], v236 offset:16896
    s_waitcnt vmcnt(5)
    ds_read_b64_tr_b16 v[148:149], v222
    ds_read_b64_tr_b16 v[150:151], v222 offset:256
    ds_read_b64_tr_b16 v[152:153], v222 offset:1024
    ds_read_b64_tr_b16 v[154:155], v222 offset:1280
    s_waitcnt lgkmcnt(12)
    v_mfma_f32_16x16x32_bf16 v[164:167], v[116:119], v[212:215], v[164:167]
    ds_read_b64_tr_b16 v[208:209], v237 offset:16384
    v_mfma_f32_16x16x32_bf16 v[172:175], v[120:123], v[212:215], v[172:175]
    ds_read_b64_tr_b16 v[210:211], v237 offset:16896
    s_waitcnt lgkmcnt(12)
    v_mfma_f32_16x16x32_bf16 v[168:171], v[116:119], v[216:219], v[168:171]
    ds_read_b64_tr_b16 v[212:213], v236 offset:20480
    v_mfma_f32_16x16x32_bf16 v[176:179], v[120:123], v[216:219], v[176:179]
    ds_read_b64_tr_b16 v[214:215], v236 offset:20992
    s_add_u32 m0, s33, 131072
    s_nop 0
    buffer_load_dwordx4 v240, s[16:19], s35 offen  lds
    s_add_u32 s35, s35, s37
    s_waitcnt lgkmcnt(12)
    v_mfma_f32_16x16x32_bf16 v[164:167], v[124:127], v[196:199], v[164:167]
    ds_read_b64_tr_b16 v[216:217], v237 offset:20480
    v_mfma_f32_16x16x32_bf16 v[172:175], v[128:131], v[196:199], v[172:175]
    ds_read_b64_tr_b16 v[218:219], v237 offset:20992
    s_waitcnt lgkmcnt(12)
    v_mfma_f32_16x16x32_bf16 v[168:171], v[124:127], v[200:203], v[168:171]
    ds_read_b64_tr_b16 v[196:197], v236 offset:24576
    v_mfma_f32_16x16x32_bf16 v[176:179], v[128:131], v[200:203], v[176:179]
    ds_read_b64_tr_b16 v[198:199], v236 offset:25088
    s_waitcnt lgkmcnt(12)
    v_mfma_f32_16x16x32_bf16 v[164:167], v[132:135], v[204:207], v[164:167]
    ds_read_b64_tr_b16 v[200:201], v237 offset:24576
    v_mfma_f32_16x16x32_bf16 v[172:175], v[136:139], v[204:207], v[172:175]
    ds_read_b64_tr_b16 v[202:203], v237 offset:25088
    s_waitcnt lgkmcnt(12)
    buffer_store_dwordx4 v[148:151], v245, s[20:23], s86 offen sc1
    s_waitcnt lgkmcnt(8)
    v_mfma_f32_16x16x32_bf16 v[168:171], v[132:135], v[208:211], v[168:171]
    ds_read_b64_tr_b16 v[204:205], v236 offset:28672
    v_mfma_f32_16x16x32_bf16 v[176:179], v[136:139], v[208:211], v[176:179]
    ds_read_b64_tr_b16 v[206:207], v236 offset:29184
    s_add_u32 m0, s33, 139264
    s_nop 0
    buffer_load_dwordx4 v240, s[16:19], s35 offen  lds
    s_add_u32 s35, s35, s37
    s_waitcnt lgkmcnt(8)
    v_mfma_f32_16x16x32_bf16 v[164:167], v[140:143], v[212:215], v[164:167]
    ds_read_b64_tr_b16 v[208:209], v237 offset:28672
    v_mfma_f32_16x16x32_bf16 v[172:175], v[144:147], v[212:215], v[172:175]
    ds_read_b64_tr_b16 v[210:211], v237 offset:29184
    s_cmp_ge_u32 s85, 648
    s_cselect_b32 s87, 0x7ff00000, s87
    buffer_store_dwordx4 v[152:155], v245, s[20:23], s87 offen sc1
    s_waitcnt lgkmcnt(8)
    v_mfma_f32_16x16x32_bf16 v[168:171], v[140:143], v[216:219], v[168:171]
    ds_read_b64_tr_b16 v[212:213], v236 offset:32768
    v_mfma_f32_16x16x32_bf16 v[176:179], v[144:147], v[216:219], v[176:179]
    ds_read_b64_tr_b16 v[214:215], v236 offset:33280
    s_mov_b32 s41, s63
    s_lshl_b32 s41, s41, 6
    s_lshl_b32 s42, s29, 5
    s_add_u32 s41, s41, s42
    v_and_b32 v224, 15, v0
    v_add_u32 v224, s41, v224
    v_lshrrev_b32 v227, 4, v0
    v_mul_u32_u24 v227, 288, v227
    s_mul_i32 s41, s47, 1152
    s_add_u32 s41, s41, 4718592
    v_mul_u32_u24 v225, 3641, v224
    v_lshrrev_b32 v225, 16, v225
    v_mul_u32_u24 v226, 18, v225
    v_sub_u32 v226, v224, v226
    v_mul_u32_u24 v225, 73728, v225
    v_lshl_add_u32 v225, v226, 4, v225
    v_add_u32 v225, v225, v227
    v_add_u32 v224, 16, v224
    v_cvt_pk_bf16_f32 v228, v164, v165
    v_cvt_pk_bf16_f32 v229, v166, v167
    v_cvt_pk_bf16_f32 v230, v172, v173
    v_cvt_pk_bf16_f32 v231, v174, v175
    s_nop 0
    v_permlane32_swap_b32 v228, v230
    v_permlane32_swap_b32 v229, v231
    buffer_store_dwordx4 v[228:231], v225, s[20:23], s41 offen sc1
    v_mul_u32_u24 v225, 3641, v224
    v_lshrrev_b32 v225, 16, v225
    v_mul_u32_u24 v226, 18, v225
    v_sub_u32 v226, v224, v226
    v_mul_u32_u24 v225, 73728, v225
    v_lshl_add_u32 v225, v226, 4, v225
    v_add_u32 v225, v225, v227
    v_add_u32 v224, 16, v224
    v_cvt_pk_bf16_f32 v232, v168, v169
    v_cvt_pk_bf16_f32 v233, v170, v171
    v_cvt_pk_bf16_f32 v234, v176, v177
    v_cvt_pk_bf16_f32 v235, v178, v179
    s_nop 0
    v_permlane32_swap_b32 v232, v234
    v_permlane32_swap_b32 v233, v235
    buffer_store_dwordx4 v[232:235], v225, s[20:23], s41 offen sc1
    s_branch K1_PRE
K1_B1V:
    s_waitcnt lgkmcnt(8)
    v_mfma_f32_16x16x32_bf16 v[148:151], v[4:7], v[196:199], 0
    s_waitcnt vmcnt(9)
    s_barrier
    ds_read_b64_tr_b16 v[216:217], v237 offset:32768
    v_mfma_f32_16x16x32_bf16 v[156:159], v[8:11], v[196:199], 0
    ds_read_b64_tr_b16 v[218:219], v237 offset:33280
    s_waitcnt lgkmcnt(8)
    v_mfma_f32_16x16x32_bf16 v[152:155], v[4:7], v[200:203], 0
    ds_read_b64_tr_b16 v[196:197], v236 offset:36864
    v_mfma_f32_16x16x32_bf16 v[160:163], v[8:11], v[200:203], 0
    ds_read_b64_tr_b16 v[198:199], v236 offset:37376
    s_add_u32 m0, s33, 49152
    s_nop 0
    buffer_load_dwordx4 v240, s[16:19], s35 offen  lds
    s_add_u32 s35, s35, s37
    s_waitcnt lgkmcnt(8)
    v_mfma_f32_16x16x32_bf16 v[148:151], v[12:15], v[204:207], v[148:151]
    ds_read_b64_tr_b16 v[200:201], v237 offset:36864
    v_mfma_f32_16x16x32_bf16 v[156:159], v[16:19], v[204:207], v[156:159]
    ds_read_b64_tr_b16 v[202:203], v237 offset:37376
    s_waitcnt lgkmcnt(8)
    v_mfma_f32_16x16x32_bf16 v[152:155], v[12:15], v[208:211], v[152:155]
    ds_read_b64_tr_b16 v[204:205], v236 offset:40960
    v_mfma_f32_16x16x32_bf16 v[160:163], v[16:19], v[208:211], v[160:163]
    ds_read_b64_tr_b16 v[206:207], v236 offset:41472
    v_mul_f32 v164, s45, v164
    v_mul_f32 v165, s45, v165
    s_waitcnt lgkmcnt(8)
    v_mfma_f32_16x16x32_bf16 v[148:151], v[20:23], v[212:215], v[148:151]
    ds_read_b64_tr_b16 v[208:209], v237 offset:40960
    v_mfma_f32_16x16x32_bf16 v[156:159], v[24:27], v[212:215], v[156:159]
    ds_read_b64_tr_b16 v[210:211], v237 offset:41472
    v_mul_f32 v166, s45, v166
    v_mul_f32 v167, s45, v167
    s_waitcnt lgkmcnt(8)
    v_mfma_f32_16x16x32_bf16 v[152:155], v[20:23], v[216:219], v[152:155]
    ds_read_b64_tr_b16 v[212:213], v236 offset:45056
    v_mfma_f32_16x16x32_bf16 v[160:163], v[24:27], v[216:219], v[160:163]
    ds_read_b64_tr_b16 v[214:215], v236 offset:45568
    s_add_u32 m0, s33, 57344
    s_nop 0
    buffer_load_dwordx4 v240, s[16:19], s35 offen  lds
    s_add_u32 s35, s35, s37
    s_waitcnt lgkmcnt(8)
    v_mfma_f32_16x16x32_bf16 v[148:151], v[28:31], v[196:199], v[148:151]
    ds_read_b64_tr_b16 v[216:217], v237 offset:45056
    v_mfma_f32_16x16x32_bf16 v[156:159], v[32:35], v[196:199], v[156:159]
    ds_read_b64_tr_b16 v[218:219], v237 offset:45568
    v_cvt_pk_bf16_f32 v228, v164, v165
    v_cvt_pk_bf16_f32 v229, v166, v167
    s_waitcnt lgkmcnt(8)
    v_mfma_f32_16x16x32_bf16 v[152:155], v[28:31], v[200:203], v[152:155]
    v_add_u32 v236, 4294918144, v236
    v_add_u32 v237, 4294918144, v237
    ds_read_b64_tr_b16 v[196:197], v236 offset:0
    v_mfma_f32_16x16x32_bf16 v[160:163], v[32:35], v[200:203], v[160:163]
    ds_read_b64_tr_b16 v[198:199], v236 offset:512
    s_waitcnt lgkmcnt(8)
    v_mfma_f32_16x16x32_bf16 v[148:151], v[36:39], v[204:207], v[148:151]
    ds_read_b64_tr_b16 v[200:201], v237 offset:0
    v_mfma_f32_16x16x32_bf16 v[156:159], v[40:43], v[204:207], v[156:159]
    ds_read_b64_tr_b16 v[202:203], v237 offset:512
    s_add_u32 s42, s44, 0
    buffer_store_dwordx2 v[228:229], v246, s[20:23], s42 offen offset:0 sc1
    s_waitcnt lgkmcnt(8)
    v_mfma_f32_16x16x32_bf16 v[152:155], v[36:39], v[208:211], v[152:155]
    ds_read_b64_tr_b16 v[204:205], v236 offset:4096
    v_mfma_f32_16x16x32_bf16 v[160:163], v[40:43], v[208:211], v[160:163]
    ds_read_b64_tr_b16 v[206:207], v236 offset:4608
    v_mul_f32 v168, s45, v168
    v_mul_f32 v169, s45, v169
    s_add_u32 m0, s33, 65536
    s_nop 0
    buffer_load_dwordx4 v240, s[16:19], s35 offen  lds
    s_add_u32 s35, s35, s37
    s_waitcnt lgkmcnt(8)
    v_mfma_f32_16x16x32_bf16 v[148:151], v[44:47], v[212:215], v[148:151]
    ds_read_b64_tr_b16 v[208:209], v237 offset:4096
    v_mfma_f32_16x16x32_bf16 v[156:159], v[48:51], v[212:215], v[156:159]
    ds_read_b64_tr_b16 v[210:211], v237 offset:4608
    s_waitcnt lgkmcnt(8)
    v_mfma_f32_16x16x32_bf16 v[152:155], v[44:47], v[216:219], v[152:155]
    ds_read_b64_tr_b16 v[212:213], v236 offset:8192
    v_mfma_f32_16x16x32_bf16 v[160:163], v[48:51], v[216:219], v[160:163]
    ds_read_b64_tr_b16 v[214:215], v236 offset:8704
    v_mul_f32 v170, s45, v170
    v_mul_f32 v171, s45, v171
    s_waitcnt lgkmcnt(8)
    v_mfma_f32_16x16x32_bf16 v[148:151], v[52:55], v[196:199], v[148:151]
    s_waitcnt vmcnt(10)
    s_barrier
    ds_read_b64_tr_b16 v[216:217], v237 offset:8192
    v_mfma_f32_16x16x32_bf16 v[156:159], v[56:59], v[196:199], v[156:159]
    ds_read_b64_tr_b16 v[218:219], v237 offset:8704
    s_mov_b32 s12, s52
    s_mov_b32 s13, s53
    s_mov_b32 s14, 5308416
    s_mov_b32 s34, s40
    s_mov_b32 s36, 589824
    v_mul_u32_u24 v239, 9216, v241
    v_add_u32 v239, v239, v242
    s_waitcnt lgkmcnt(8)
    v_mfma_f32_16x16x32_bf16 v[152:155], v[52:55], v[200:203], v[152:155]
    ds_read_b64_tr_b16 v[196:197], v236 offset:12288
    v_mfma_f32_16x16x32_bf16 v[160:163], v[56:59], v[200:203], v[160:163]
    ds_read_b64_tr_b16 v[198:199], v236 offset:12800
    v_cvt_pk_bf16_f32 v230, v168, v169
    v_cvt_pk_bf16_f32 v231, v170, v171
    s_add_u32 m0, s33, 73728
    s_nop 0
    buffer_load_dwordx4 v239, s[12:15], s34 offen  lds
    s_add_u32 s34, s34, s36
    s_waitcnt lgkmcnt(8)
    v_mfma_f32_16x16x32_bf16 v[148:151], v[60:63], v[204:207], v[148:151]
    ds_read_b64_tr_b16 v[200:201], v237 offset:12288
    v_mfma_f32_16x16x32_bf16 v[156:159], v[64:67], v[204:207], v[156:159]
    ds_read_b64_tr_b16 v[202:203], v237 offset:12800
    s_add_u32 s42, s44, 65536
    buffer_store_dwordx2 v[230:231], v246, s[20:23], s42 offen offset:0 sc1
    s_waitcnt lgkmcnt(8)
    v_mfma_f32_16x16x32_bf16 v[152:155], v[60:63], v[208:211], v[152:155]
    ds_read_b64_tr_b16 v[204:205], v236 offset:16384
    v_mfma_f32_16x16x32_bf16 v[160:163], v[64:67], v[208:211], v[160:163]
    ds_read_b64_tr_b16 v[206:207], v236 offset:16896
    s_waitcnt lgkmcnt(8)
    v_mfma_f32_16x16x32_bf16 v[148:151], v[68:71], v[212:215], v[148:151]
    ds_read_b64_tr_b16 v[208:209], v237 offset:16384
    v_mfma_f32_16x16x32_bf16 v[156:159], v[72:75], v[212:215], v[156:159]
    ds_read_b64_tr_b16 v[210:211], v237 offset:16896
    v_mul_f32 v172, s45, v172
    v_mul_f32 v173, s45, v173
    s_waitcnt lgkmcnt(8)
    v_mfma_f32_16x16x32_bf16 v[152:155], v[68:71], v[216:219], v[152:155]
    ds_read_b64_tr_b16 v[212:213], v236 offset:20480
    v_mfma_f32_16x16x32_bf16 v[160:163], v[72:75], v[216:219], v[160:163]
    ds_read_b64_tr_b16 v[214:215], v236 offset:20992
    s_add_u32 m0, s33, 81920
    s_nop 0
    buffer_load_dwordx4 v239, s[12:15], s34 offen  lds
    s_add_u32 s34, s34, s36
    s_waitcnt lgkmcnt(8)
    v_mfma_f32_16x16x32_bf16 v[148:151], v[76:79], v[196:199], v[148:151]
    ds_read_b64_tr_b16 v[216:217], v237 offset:20480
    v_mfma_f32_16x16x32_bf16 v[156:159], v[80:83], v[196:199], v[156:159]
    ds_read_b64_tr_b16 v[218:219], v237 offset:20992
    v_mul_f32 v174, s45, v174
    v_mul_f32 v175, s45, v175
    s_waitcnt lgkmcnt(8)
    v_mfma_f32_16x16x32_bf16 v[152:155], v[76:79], v[200:203], v[152:155]
    ds_read_b64_tr_b16 v[196:197], v236 offset:24576
    v_mfma_f32_16x16x32_bf16 v[160:163], v[80:83], v[200:203], v[160:163]
    ds_read_b64_tr_b16 v[198:199], v236 offset:25088
    v_cvt_pk_bf16_f32 v232, v172, v173
    v_cvt_pk_bf16_f32 v233, v174, v175
    s_waitcnt lgkmcnt(8)
    v_mfma_f32_16x16x32_bf16 v[148:151], v[84:87], v[204:207], v[148:151]
    ds_read_b64_tr_b16 v[200:201], v237 offset:24576
    v_mfma_f32_16x16x32_bf16 v[156:159], v[88:91], v[204:207], v[156:159]
    ds_read_b64_tr_b16 v[202:203], v237 offset:25088
    s_waitcnt lgkmcnt(8)
    v_mfma_f32_16x16x32_bf16 v[152:155], v[84:87], v[208:211], v[152:155]
    ds_read_b64_tr_b16 v[204:205], v236 offset:28672
    v_mfma_f32_16x16x32_bf16 v[160:163], v[88:91], v[208:211], v[160:163]
    ds_read_b64_tr_b16 v[206:207], v236 offset:29184
    s_add_u32 s42, s44, 0
    buffer_store_dwordx2 v[232:233], v246, s[20:23], s42 offen offset:128 sc1
    s_add_u32 m0, s33, 90112
    s_nop 0
    buffer_load_dwordx4 v239, s[12:15], s34 offen  lds
    s_add_u32 s34, s34, s36
    s_waitcnt lgkmcnt(8)
    v_mfma_f32_16x16x32_bf16 v[148:151], v[92:95], v[212:215], v[148:151]
    ds_read_b64_tr_b16 v[208:209], v237 offset:28672
    v_mfma_f32_16x16x32_bf16 v[156:159], v[96:99], v[212:215], v[156:159]
    ds_read_b64_tr_b16 v[210:211], v237 offset:29184
    s_waitcnt lgkmcnt(8)
    v_mfma_f32_16x16x32_bf16 v[152:155], v[92:95], v[216:219], v[152:155]
    ds_read_b64_tr_b16 v[212:213], v236 offset:32768
    v_mfma_f32_16x16x32_bf16 v[160:163], v[96:99], v[216:219], v[160:163]
    ds_read_b64_tr_b16 v[214:215], v236 offset:33280
    v_mul_f32 v176, s45, v176
    v_mul_f32 v177, s45, v177
    s_waitcnt lgkmcnt(8)
    v_mfma_f32_16x16x32_bf16 v[148:151], v[100:103], v[196:199], v[148:151]
    s_waitcnt vmcnt(12)
    s_barrier
    ds_read_b64_tr_b16 v[216:217], v237 offset:32768
    v_mfma_f32_16x16x32_bf16 v[156:159], v[104:107], v[196:199], v[156:159]
    ds_read_b64_tr_b16 v[218:219], v237 offset:33280
    v_mul_f32 v178, s45, v178
    v_mul_f32 v179, s45, v179
    s_waitcnt lgkmcnt(8)
    v_mfma_f32_16x16x32_bf16 v[152:155], v[100:103], v[200:203], v[152:155]
    ds_read_b64_tr_b16 v[196:197], v236 offset:36864
    v_mfma_f32_16x16x32_bf16 v[160:163], v[104:107], v[200:203], v[160:163]
    ds_read_b64_tr_b16 v[198:199], v236 offset:37376
    s_add_u32 m0, s33, 0
    s_nop 0
    buffer_load_dwordx4 v239, s[12:15], s34 offen  lds
    s_add_u32 s34, s34, s36
    s_waitcnt lgkmcnt(8)
    v_mfma_f32_16x16x32_bf16 v[148:151], v[108:111], v[204:207], v[148:151]
    ds_read_b64_tr_b16 v[200:201], v237 offset:36864
    v_mfma_f32_16x16x32_bf16 v[156:159], v[112:115], v[204:207], v[156:159]
    ds_read_b64_tr_b16 v[202:203], v237 offset:37376
    v_cvt_pk_bf16_f32 v234, v176, v177
    v_cvt_pk_bf16_f32 v235, v178, v179
    s_waitcnt lgkmcnt(8)
    v_mfma_f32_16x16x32_bf16 v[152:155], v[108:111], v[208:211], v[152:155]
    ds_read_b64_tr_b16 v[204:205], v236 offset:40960
    v_mfma_f32_16x16x32_bf16 v[160:163], v[112:115], v[208:211], v[160:163]
    ds_read_b64_tr_b16 v[206:207], v236 offset:41472
    s_waitcnt lgkmcnt(8)
    v_mfma_f32_16x16x32_bf16 v[148:151], v[116:119], v[212:215], v[148:151]
    ds_read_b64_tr_b16 v[208:209], v237 offset:40960
    v_mfma_f32_16x16x32_bf16 v[156:159], v[120:123], v[212:215], v[156:159]
    ds_read_b64_tr_b16 v[210:211], v237 offset:41472
    s_add_u32 s42, s44, 65536
    buffer_store_dwordx2 v[234:235], v246, s[20:23], s42 offen offset:128 sc1
    s_waitcnt lgkmcnt(8)
    v_mfma_f32_16x16x32_bf16 v[152:155], v[116:119], v[216:219], v[152:155]
    ds_read_b64_tr_b16 v[212:213], v236 offset:45056
    v_mfma_f32_16x16x32_bf16 v[160:163], v[120:123], v[216:219], v[160:163]
    ds_read_b64_tr_b16 v[214:215], v236 offset:45568
    s_add_u32 m0, s33, 8192
    s_nop 0
    buffer_load_dwordx4 v239, s[12:15], s34 offen  lds
    s_add_u32 s34, s34, s36
    s_waitcnt lgkmcnt(8)
    v_mfma_f32_16x16x32_bf16 v[148:151], v[124:127], v[196:199], v[148:151]
    ds_read_b64_tr_b16 v[216:217], v237 offset:45056
    v_mfma_f32_16x16x32_bf16 v[156:159], v[128:131], v[196:199], v[156:159]
    ds_read_b64_tr_b16 v[218:219], v237 offset:45568
    s_waitcnt lgkmcnt(8)
    v_mfma_f32_16x16x32_bf16 v[152:155], v[124:127], v[200:203], v[152:155]
    v_add_u32 v236, 98304, v236
    v_add_u32 v237, 98304, v237
    ds_read_b64_tr_b16 v[196:197], v236 offset:0
    v_mfma_f32_16x16x32_bf16 v[160:163], v[128:131], v[200:203], v[160:163]
    ds_read_b64_tr_b16 v[198:199], v236 offset:512
    s_waitcnt lgkmcnt(8)
    v_mfma_f32_16x16x32_bf16 v[148:151], v[132:135], v[204:207], v[148:151]
    ds_read_b64_tr_b16 v[200:201], v237 offset:0
    v_mfma_f32_16x16x32_bf16 v[156:159], v[136:139], v[204:207], v[156:159]
    ds_read_b64_tr_b16 v[202:203], v237 offset:512
    s_waitcnt lgkmcnt(8)
    v_mfma_f32_16x16x32_bf16 v[152:155], v[132:135], v[208:211], v[152:155]
    ds_read_b64_tr_b16 v[204:205], v236 offset:4096
    v_mfma_f32_16x16x32_bf16 v[160:163], v[136:139], v[208:211], v[160:163]
    ds_read_b64_tr_b16 v[206:207], v236 offset:4608
    s_add_u32 m0, s33, 16384
    s_nop 0
    buffer_load_dwordx4 v239, s[12:15], s34 offen  lds
    s_add_u32 s34, s34, s36
    s_waitcnt lgkmcnt(8)
    v_mfma_f32_16x16x32_bf16 v[148:151], v[140:143], v[212:215], v[148:151]
    ds_read_b64_tr_b16 v[208:209], v237 offset:4096
    v_mfma_f32_16x16x32_bf16 v[156:159], v[144:147], v[212:215], v[156:159]
    ds_read_b64_tr_b16 v[210:211], v237 offset:4608
    s_waitcnt lgkmcnt(8)
    v_mfma_f32_16x16x32_bf16 v[152:155], v[140:143], v[216:219], v[152:155]
    ds_read_b64_tr_b16 v[212:213], v236 offset:8192
    v_mfma_f32_16x16x32_bf16 v[160:163], v[144:147], v[216:219], v[160:163]
    ds_read_b64_tr_b16 v[214:215], v236 offset:8704
    s_waitcnt lgkmcnt(8)
    v_mfma_f32_16x16x32_bf16 v[164:167], v[4:7], v[196:199], 0
    s_waitcnt vmcnt(13)
    s_barrier
    ds_read_b64_tr_b16 v[216:217], v237 offset:8192
    v_mfma_f32_16x16x32_bf16 v[172:175], v[8:11], v[196:199], 0
    ds_read_b64_tr_b16 v[218:219], v237 offset:8704
    s_waitcnt lgkmcnt(8)
    v_mfma_f32_16x16x32_bf16 v[168:171], v[4:7], v[200:203], 0
    ds_read_b64_tr_b16 v[196:197], v236 offset:12288
    v_mfma_f32_16x16x32_bf16 v[176:179], v[8:11], v[200:203], 0
    ds_read_b64_tr_b16 v[198:199], v236 offset:12800
    s_add_u32 m0, s33, 24576
    s_nop 0
    buffer_load_dwordx4 v239, s[12:15], s34 offen  lds
    s_add_u32 s34, s34, s36
    s_waitcnt lgkmcnt(8)
    v_mfma_f32_16x16x32_bf16 v[164:167], v[12:15], v[204:207], v[164:167]
    ds_read_b64_tr_b16 v[200:201], v237 offset:12288
    v_mfma_f32_16x16x32_bf16 v[172:175], v[16:19], v[204:207], v[172:175]
    ds_read_b64_tr_b16 v[202:203], v237 offset:12800
    s_waitcnt lgkmcnt(8)
    v_mfma_f32_16x16x32_bf16 v[168:171], v[12:15], v[208:211], v[168:171]
    ds_read_b64_tr_b16 v[204:205], v236 offset:16384
    v_mfma_f32_16x16x32_bf16 v[176:179], v[16:19], v[208:211], v[176:179]
    ds_read_b64_tr_b16 v[206:207], v236 offset:16896
    s_add_u32 s41, s93, -2
    s_lshl_b32 s41, s41, 6
    s_waitcnt lgkmcnt(8)
    v_mfma_f32_16x16x32_bf16 v[164:167], v[20:23], v[212:215], v[164:167]
    ds_read_b64_tr_b16 v[208:209], v237 offset:16384
    v_mfma_f32_16x16x32_bf16 v[172:175], v[24:27], v[212:215], v[172:175]
    ds_read_b64_tr_b16 v[210:211], v237 offset:16896
    s_lshl_b32 s42, s29, 5
    s_add_u32 s41, s41, s42
    s_waitcnt lgkmcnt(8)
    v_mfma_f32_16x16x32_bf16 v[168:171], v[20:23], v[216:219], v[168:171]
    ds_read_b64_tr_b16 v[212:213], v236 offset:20480
    v_mfma_f32_16x16x32_bf16 v[176:179], v[24:27], v[216:219], v[176:179]
    ds_read_b64_tr_b16 v[214:215], v236 offset:20992
    v_and_b32 v224, 15, v0
    v_add_u32 v224, s41, v224
    s_add_u32 m0, s33, 32768
    s_nop 0
    buffer_load_dwordx4 v239, s[12:15], s34 offen  lds
    s_add_u32 s34, s34, s36
    s_waitcnt lgkmcnt(8)
    v_mfma_f32_16x16x32_bf16 v[164:167], v[28:31], v[196:199], v[164:167]
    ds_read_b64_tr_b16 v[216:217], v237 offset:20480
    v_mfma_f32_16x16x32_bf16 v[172:175], v[32:35], v[196:199], v[172:175]
    ds_read_b64_tr_b16 v[218:219], v237 offset:20992
    s_waitcnt lgkmcnt(8)
    v_mfma_f32_16x16x32_bf16 v[168:171], v[28:31], v[200:203], v[168:171]
    ds_read_b64_tr_b16 v[196:197], v236 offset:24576
    v_mfma_f32_16x16x32_bf16 v[176:179], v[32:35], v[200:203], v[176:179]
    ds_read_b64_tr_b16 v[198:199], v236 offset:25088
    v_lshrrev_b32 v227, 4, v0
    v_mul_u32_u24 v227, 288, v227
    s_waitcnt lgkmcnt(8)
    v_mfma_f32_16x16x32_bf16 v[164:167], v[36:39], v[204:207], v[164:167]
    ds_read_b64_tr_b16 v[200:201], v237 offset:24576
    v_mfma_f32_16x16x32_bf16 v[172:175], v[40:43], v[204:207], v[172:175]
    ds_read_b64_tr_b16 v[202:203], v237 offset:25088
    s_mul_i32 s41, s47, 1152
    s_add_u32 s41, s41, 4718592
    s_waitcnt lgkmcnt(8)
    v_mfma_f32_16x16x32_bf16 v[168:171], v[36:39], v[208:211], v[168:171]
    ds_read_b64_tr_b16 v[204:205], v236 offset:28672
    v_mfma_f32_16x16x32_bf16 v[176:179], v[40:43], v[208:211], v[176:179]
    ds_read_b64_tr_b16 v[206:207], v236 offset:29184
    v_mul_u32_u24 v225, 3641, v224
    v_lshrrev_b32 v225, 16, v225
    s_add_u32 m0, s33, 40960
    s_nop 0
    buffer_load_dwordx4 v239, s[12:15], s34 offen  lds
    s_add_u32 s34, s34, s36
    s_waitcnt lgkmcnt(8)
    v_mfma_f32_16x16x32_bf16 v[164:167], v[44:47], v[212:215], v[164:167]
    ds_read_b64_tr_b16 v[208:209], v237 offset:28672
    v_mfma_f32_16x16x32_bf16 v[172:175], v[48:51], v[212:215], v[172:175]
    ds_read_b64_tr_b16 v[210:211], v237 offset:29184
    s_waitcnt lgkmcnt(8)
    v_mfma_f32_16x16x32_bf16 v[168:171], v[44:47], v[216:219], v[168:171]
    ds_read_b64_tr_b16 v[212:213], v236 offset:32768
    v_mfma_f32_16x16x32_bf16 v[176:179], v[48:51], v[216:219], v[176:179]
    ds_read_b64_tr_b16 v[214:215], v236 offset:33280
    v_mul_u32_u24 v226, 18, v225
    v_sub_u32 v226, v224, v226
    s_waitcnt lgkmcnt(8)
    v_mfma_f32_16x16x32_bf16 v[164:167], v[52:55], v[196:199], v[164:167]
    s_waitcnt vmcnt(12)
    s_barrier
    ds_read_b64_tr_b16 v[216:217], v237 offset:32768
    v_mfma_f32_16x16x32_bf16 v[172:175], v[56:59], v[196:199], v[172:175]
    ds_read_b64_tr_b16 v[218:219], v237 offset:33280
    v_mul_u32_u24 v225, 73728, v225
    v_lshl_add_u32 v225, v226, 4, v225
    s_mov_b32 s16, s54
    s_mov_b32 s17, s55
    s_mov_b32 s18, 5308416
    s_mov_b32 s35, s40
    s_mov_b32 s37, 589824
    v_mov_b32 v240, v239
    s_waitcnt lgkmcnt(8)
    v_mfma_f32_16x16x32_bf16 v[168:171], v[52:55], v[200:203], v[168:171]
    ds_read_b64_tr_b16 v[196:197], v236 offset:36864
    v_mfma_f32_16x16x32_bf16 v[176:179], v[56:59], v[200:203], v[176:179]
    ds_read_b64_tr_b16 v[198:199], v236 offset:37376
    v_add_u32 v225, v225, v227
    v_add_u32 v224, 16, v224
    s_add_u32 m0, s33, 98304
    s_nop 0
    buffer_load_dwordx4 v240, s[16:19], s35 offen  lds
    s_add_u32 s35, s35, s37
    s_waitcnt lgkmcnt(8)
    v_mfma_f32_16x16x32_bf16 v[164:167], v[60:63], v[204:207], v[164:167]
    ds_read_b64_tr_b16 v[200:201], v237 offset:36864
    v_mfma_f32_16x16x32_bf16 v[172:175], v[64:67], v[204:207], v[172:175]
    ds_read_b64_tr_b16 v[202:203], v237 offset:37376
    s_waitcnt lgkmcnt(8)
    v_mfma_f32_16x16x32_bf16 v[168:171], v[60:63], v[208:211], v[168:171]
    ds_read_b64_tr_b16 v[204:205], v236 offset:40960
    v_mfma_f32_16x16x32_bf16 v[176:179], v[64:67], v[208:211], v[176:179]
    ds_read_b64_tr_b16 v[206:207], v236 offset:41472
    v_cvt_pk_bf16_f32 v228, v148, v149
    v_cvt_pk_bf16_f32 v229, v150, v151
    s_waitcnt lgkmcnt(8)
    v_mfma_f32_16x16x32_bf16 v[164:167], v[68:71], v[212:215], v[164:167]
    ds_read_b64_tr_b16 v[208:209], v237 offset:40960
    v_mfma_f32_16x16x32_bf16 v[172:175], v[72:75], v[212:215], v[172:175]
    ds_read_b64_tr_b16 v[210:211], v237 offset:41472
    v_cvt_pk_bf16_f32 v230, v156, v157
    v_cvt_pk_bf16_f32 v231, v158, v159
    s_waitcnt lgkmcnt(8)
    v_mfma_f32_16x16x32_bf16 v[168:171], v[68:71], v[216:219], v[168:171]
    ds_read_b64_tr_b16 v[212:213], v236 offset:45056
    v_mfma_f32_16x16x32_bf16 v[176:179], v[72:75], v[216:219], v[176:179]
    ds_read_b64_tr_b16 v[214:215], v236 offset:45568
    v_permlane32_swap_b32 v228, v230
    v_permlane32_swap_b32 v229, v231
    s_add_u32 m0, s33, 106496
    s_nop 0
    buffer_load_dwordx4 v240, s[16:19], s35 offen  lds
    s_add_u32 s35, s35, s37
    s_waitcnt lgkmcnt(8)
    v_mfma_f32_16x16x32_bf16 v[164:167], v[76:79], v[196:199], v[164:167]
    ds_read_b64_tr_b16 v[216:217], v237 offset:45056
    v_mfma_f32_16x16x32_bf16 v[172:175], v[80:83], v[196:199], v[172:175]
    ds_read_b64_tr_b16 v[218:219], v237 offset:45568
    s_waitcnt lgkmcnt(8)
    v_mfma_f32_16x16x32_bf16 v[168:171], v[76:79], v[200:203], v[168:171]
    v_add_u32 v236, 4294918144, v236
    v_add_u32 v237, 4294918144, v237
    ds_read_b64_tr_b16 v[196:197], v236 offset:0
    v_mfma_f32_16x16x32_bf16 v[176:179], v[80:83], v[200:203], v[176:179]
    ds_read_b64_tr_b16 v[198:199], v236 offset:512
    buffer_store_dwordx4 v[228:231], v225, s[20:23], s41 offen sc1
    v_mul_u32_u24 v225, 3641, v224
    s_waitcnt lgkmcnt(8)
    v_mfma_f32_16x16x32_bf16 v[164:167], v[84:87], v[204:207], v[164:167]
    ds_read_b64_tr_b16 v[200:201], v237 offset:0
    v_mfma_f32_16x16x32_bf16 v[172:175], v[88:91], v[204:207], v[172:175]
    ds_read_b64_tr_b16 v[202:203], v237 offset:512
    v_lshrrev_b32 v225, 16, v225
    v_mul_u32_u24 v226, 18, v225
    s_waitcnt lgkmcnt(8)
    v_mfma_f32_16x16x32_bf16 v[168:171], v[84:87], v[208:211], v[168:171]
    ds_read_b64_tr_b16 v[204:205], v236 offset:4096
    v_mfma_f32_16x16x32_bf16 v[176:179], v[88:91], v[208:211], v[176:179]
    ds_read_b64_tr_b16 v[206:207], v236 offset:4608
    v_sub_u32 v226, v224, v226
    v_mul_u32_u24 v225, 73728, v225
    s_add_u32 m0, s33, 114688
    s_nop 0
    buffer_load_dwordx4 v240, s[16:19], s35 offen  lds
    s_add_u32 s35, s35, s37
    s_waitcnt lgkmcnt(8)
    v_mfma_f32_16x16x32_bf16 v[164:167], v[92:95], v[212:215], v[164:167]
    ds_read_b64_tr_b16 v[208:209], v237 offset:4096
    v_mfma_f32_16x16x32_bf16 v[172:175], v[96:99], v[212:215], v[172:175]
    ds_read_b64_tr_b16 v[210:211], v237 offset:4608
    s_waitcnt lgkmcnt(8)
    v_mfma_f32_16x16x32_bf16 v[168:171], v[92:95], v[216:219], v[168:171]
    ds_read_b64_tr_b16 v[212:213], v236 offset:8192
    v_mfma_f32_16x16x32_bf16 v[176:179], v[96:99], v[216:219], v[176:179]
    ds_read_b64_tr_b16 v[214:215], v236 offset:8704
    v_lshl_add_u32 v225, v226, 4, v225
    v_add_u32 v225, v225, v227
    s_waitcnt lgkmcnt(8)
    v_mfma_f32_16x16x32_bf16 v[164:167], v[100:103], v[196:199], v[164:167]
    s_waitcnt vmcnt(11)
    s_barrier
    ds_read_b64_tr_b16 v[216:217], v237 offset:8192
    v_mfma_f32_16x16x32_bf16 v[172:175], v[104:107], v[196:199], v[172:175]
    ds_read_b64_tr_b16 v[218:219], v237 offset:8704
    v_add_u32 v224, 16, v224
    v_cvt_pk_bf16_f32 v232, v152, v153
    s_waitcnt lgkmcnt(8)
    v_mfma_f32_16x16x32_bf16 v[168:171], v[100:103], v[200:203], v[168:171]
    ds_read_b64_tr_b16 v[196:197], v236 offset:12288
    v_mfma_f32_16x16x32_bf16 v[176:179], v[104:107], v[200:203], v[176:179]
    ds_read_b64_tr_b16 v[198:199], v236 offset:12800
    v_cvt_pk_bf16_f32 v233, v154, v155
    v_cvt_pk_bf16_f32 v234, v160, v161
    s_add_u32 m0, s33, 122880
    s_nop 0
    buffer_load_dwordx4 v240, s[16:19], s35 offen  lds
    s_add_u32 s35, s35, s37
    s_waitcnt lgkmcnt(8)
    v_mfma_f32_16x16x32_bf16 v[164:167], v[108:111], v[204:207], v[164:167]
    ds_read_b64_tr_b16 v[200:201], v237 offset:12288
    v_mfma_f32_16x16x32_bf16 v[172:175], v[112:115], v[204:207], v[172:175]
    ds_read_b64_tr_b16 v[202:203], v237 offset:12800
    s_waitcnt lgkmcnt(8)
    v_mfma_f32_16x16x32_bf16 v[168:171], v[108:111], v[208:211], v[168:171]
    ds_read_b64_tr_b16 v[204:205], v236 offset:16384
    v_mfma_f32_16x16x32_bf16 v[176:179], v[112:115], v[208:211], v[176:179]
    ds_read_b64_tr_b16 v[206:207], v236 offset:16896
    v_cvt_pk_bf16_f32 v235, v162, v163
    v_permlane32_swap_b32 v232, v234
    s_waitcnt lgkmcnt(8)
    v_mfma_f32_16x16x32_bf16 v[164:167], v[116:119], v[212:215], v[164:167]
    ds_read_b64_tr_b16 v[208:209], v237 offset:16384
    v_mfma_f32_16x16x32_bf16 v[172:175], v[120:123], v[212:215], v[172:175]
    ds_read_b64_tr_b16 v[210:211], v237 offset:16896
    v_permlane32_swap_b32 v233, v235
    buffer_store_dwordx4 v[232:235], v225, s[20:23], s41 offen sc1
    s_waitcnt lgkmcnt(8)
    v_mfma_f32_16x16x32_bf16 v[168:171], v[116:119], v[216:219], v[168:171]
    ds_read_b64_tr_b16 v[212:213], v236 offset:20480
    v_mfma_f32_16x16x32_bf16 v[176:179], v[120:123], v[216:219], v[176:179]
    ds_read_b64_tr_b16 v[214:215], v236 offset:20992
    s_add_u32 m0, s33, 131072
    s_nop 0
    buffer_load_dwordx4 v240, s[16:19], s35 offen  lds
    s_add_u32 s35, s35, s37
    s_waitcnt lgkmcnt(8)
    v_mfma_f32_16x16x32_bf16 v[164:167], v[124:127], v[196:199], v[164:167]
    ds_read_b64_tr_b16 v[216:217], v237 offset:20480
    v_mfma_f32_16x16x32_bf16 v[172:175], v[128:131], v[196:199], v[172:175]
    ds_read_b64_tr_b16 v[218:219], v237 offset:20992
    s_waitcnt lgkmcnt(8)
    v_mfma_f32_16x16x32_bf16 v[168:171], v[124:127], v[200:203], v[168:171]
    ds_read_b64_tr_b16 v[196:197], v236 offset:24576
    v_mfma_f32_16x16x32_bf16 v[176:179], v[128:131], v[200:203], v[176:179]
    ds_read_b64_tr_b16 v[198:199], v236 offset:25088
    s_waitcnt lgkmcnt(8)
    v_mfma_f32_16x16x32_bf16 v[164:167], v[132:135], v[204:207], v[164:167]
    ds_read_b64_tr_b16 v[200:201], v237 offset:24576
    v_mfma_f32_16x16x32_bf16 v[172:175], v[136:139], v[204:207], v[172:175]
    ds_read_b64_tr_b16 v[202:203], v237 offset:25088
    s_waitcnt lgkmcnt(8)
    v_mfma_f32_16x16x32_bf16 v[168:171], v[132:135], v[208:211], v[168:171]
    ds_read_b64_tr_b16 v[204:205], v236 offset:28672
    v_mfma_f32_16x16x32_bf16 v[176:179], v[136:139], v[208:211], v[176:179]
    ds_read_b64_tr_b16 v[206:207], v236 offset:29184
    s_add_u32 m0, s33, 139264
    s_nop 0
    buffer_load_dwordx4 v240, s[16:19], s35 offen  lds
    s_add_u32 s35, s35, s37
    s_waitcnt lgkmcnt(8)
    v_mfma_f32_16x16x32_bf16 v[164:167], v[140:143], v[212:215], v[164:167]
    ds_read_b64_tr_b16 v[208:209], v237 offset:28672
    v_mfma_f32_16x16x32_bf16 v[172:175], v[144:147], v[212:215], v[172:175]
    ds_read_b64_tr_b16 v[210:211], v237 offset:29184
    s_waitcnt lgkmcnt(8)
    v_mfma_f32_16x16x32_bf16 v[168:171], v[140:143], v[216:219], v[168:171]
    ds_read_b64_tr_b16 v[212:213], v236 offset:32768
    v_mfma_f32_16x16x32_bf16 v[176:179], v[144:147], v[216:219], v[176:179]
    ds_read_b64_tr_b16 v[214:215], v236 offset:33280
    s_mov_b32 s41, s63
    s_lshl_b32 s41, s41, 6
    s_lshl_b32 s42, s29, 5
    s_add_u32 s41, s41, s42
    v_and_b32 v224, 15, v0
    v_add_u32 v224, s41, v224
    v_lshrrev_b32 v227, 4, v0
    v_mul_u32_u24 v227, 288, v227
    s_mul_i32 s41, s47, 1152
    s_add_u32 s41, s41, 4718592
    v_mul_u32_u24 v225, 3641, v224
    v_lshrrev_b32 v225, 16, v225
    v_mul_u32_u24 v226, 18, v225
    v_sub_u32 v226, v224, v226
    v_mul_u32_u24 v225, 73728, v225
    v_lshl_add_u32 v225, v226, 4, v225
    v_add_u32 v225, v225, v227
    v_add_u32 v224, 16, v224
    v_cvt_pk_bf16_f32 v228, v164, v165
    v_cvt_pk_bf16_f32 v229, v166, v167
    v_cvt_pk_bf16_f32 v230, v172, v173
    v_cvt_pk_bf16_f32 v231, v174, v175
    s_nop 0
    v_permlane32_swap_b32 v228, v230
    v_permlane32_swap_b32 v229, v231
    buffer_store_dwordx4 v[228:231], v225, s[20:23], s41 offen sc1
    v_mul_u32_u24 v225, 3641, v224
    v_lshrrev_b32 v225, 16, v225
    v_mul_u32_u24 v226, 18, v225
    v_sub_u32 v226, v224, v226
    v_mul_u32_u24 v225, 73728, v225
    v_lshl_add_u32 v225, v226, 4, v225
    v_add_u32 v225, v225, v227
    v_add_u32 v224, 16, v224
    v_cvt_pk_bf16_f32 v232, v168, v169
    v_cvt_pk_bf16_f32 v233, v170, v171
    v_cvt_pk_bf16_f32 v234, v176, v177
    v_cvt_pk_bf16_f32 v235, v178, v179
    s_nop 0
    v_permlane32_swap_b32 v232, v234
    v_permlane32_swap_b32 v233, v235
    buffer_store_dwordx4 v[232:235], v225, s[20:23], s41 offen sc1
K1_PRE:
    s_mov_b32 s4, s98
    s_mov_b32 s5, s99
    s_mov_b32 s6, 256
    s_mov_b32 s7, 0x20000
    v_mov_b32 v254, 0
    v_mov_b32 v253, 0
    s_cmp_eq_u32 s28, 0
    s_cselect_b32 s92, s46, 99
    s_mov_b32 s8, s56
    s_mov_b32 s9, s57
    s_mov_b32 s10, 5308416
    s_mov_b32 s11, 0x20000
    s_lshl_b32 s61, s2, 3
    s_add_u32 s61, s61, s28
    s_lshl_b32 s89, s84, 3
    s_add_u32 s89, s89, s28
    s_add_u32 s89, s89, 2048
    s_cmp_ge_u32 s32, 11
    s_cselect_b32 s89, s89, 4000
    s_lshl_b32 s60, s28, 11
    s_add_u32 s60, s60, 147456
    v_lshrrev_b32 v245, 2, v0
    v_mul_u32_u24 v245, 1152, v245
    v_and_b32 v238, 3, v0
    v_lshl_add_u32 v245, v238, 4, v245
    v_add_u32 v238, s60, v243
    s_sub_u32 s92, s46, 1
    s_cmp_ge_u32 s32, 11
    s_cselect_b32 s92, 2, s92
    s_cmp_eq_u32 s28, 0
    s_cselect_b32 s92, s92, 99
K1_LOOP:
    s_waitcnt lgkmcnt(8)
    v_mfma_f32_16x16x32_bf16 v[148:151], v[196:199], v[4:7], 0
    s_waitcnt vmcnt(9)
    s_barrier
    ds_read_b64_tr_b16 v[216:217], v237 offset:32768
    v_mfma_f32_16x16x32_bf16 v[156:159], v[196:199], v[8:11], 0
    ds_read_b64_tr_b16 v[218:219], v237 offset:33280
    s_waitcnt lgkmcnt(8)
    v_mfma_f32_16x16x32_bf16 v[152:155], v[200:203], v[4:7], 0
    ds_read_b64_tr_b16 v[196:197], v236 offset:36864
    v_mfma_f32_16x16x32_bf16 v[160:163], v[200:203], v[8:11], 0
    ds_read_b64_tr_b16 v[198:199], v236 offset:37376
    s_add_u32 m0, s33, 49152
    s_nop 0
    buffer_load_dwordx4 v240, s[16:19], s35 offen  lds
    s_add_u32 s35, s35, s37
    s_waitcnt lgkmcnt(8)
    v_mfma_f32_16x16x32_bf16 v[148:151], v[204:207], v[12:15], v[148:151]
    ds_read_b64_tr_b16 v[200:201], v237 offset:36864
    v_mfma_f32_16x16x32_bf16 v[156:159], v[204:207], v[16:19], v[156:159]
    ds_read_b64_tr_b16 v[202:203], v237 offset:37376
    s_cmp_ge_u32 s61, 2592
    s_cbranch_scc1 K1_G1
    s_mul_i32 s41, s61, 3641
    s_lshr_b32 s41, s41, 16
    s_mul_i32 s42, s41, 18
    s_sub_u32 s42, s61, s42
    s_mul_i32 s41, s41, 36864
    s_lshl_b32 s42, s42, 6
    s_add_u32 s41, s41, s42
    s_mov_b32 m0, s60
    s_add_u32 s42, s41, 17408
    buffer_load_dwordx4 v245, s[8:11], s41 offen lds
    buffer_load_dwordx4 v245, s[8:11], s42 offen offset:1024 lds
K1_G1:
    s_waitcnt lgkmcnt(8)
    v_mfma_f32_16x16x32_bf16 v[152:155], v[208:211], v[12:15], v[152:155]
    ds_read_b64_tr_b16 v[204:205], v236 offset:40960
    v_mfma_f32_16x16x32_bf16 v[160:163], v[208:211], v[16:19], v[160:163]
    ds_read_b64_tr_b16 v[206:207], v236 offset:41472
    v_mul_f32 v180, v180, v164
    v_mul_f32 v181, v181, v165
    s_waitcnt lgkmcnt(8)
    v_mfma_f32_16x16x32_bf16 v[148:151], v[212:215], v[20:23], v[148:151]
    ds_read_b64_tr_b16 v[208:209], v237 offset:40960
    v_mfma_f32_16x16x32_bf16 v[156:159], v[212:215], v[24:27], v[156:159]
    ds_read_b64_tr_b16 v[210:211], v237 offset:41472
    v_mul_f32 v182, v182, v166
    v_mul_f32 v183, v183, v167
    s_waitcnt lgkmcnt(8)
    v_mfma_f32_16x16x32_bf16 v[152:155], v[216:219], v[20:23], v[152:155]
    ds_read_b64_tr_b16 v[212:213], v236 offset:45056
    v_mfma_f32_16x16x32_bf16 v[160:163], v[216:219], v[24:27], v[160:163]
    ds_read_b64_tr_b16 v[214:215], v236 offset:45568
    v_mul_f32 v184, v184, v168
    v_mul_f32 v185, v185, v169
    s_add_u32 m0, s33, 57344
    s_nop 0
    buffer_load_dwordx4 v240, s[16:19], s35 offen  lds
    s_add_u32 s35, s35, s37
    s_waitcnt lgkmcnt(8)
    v_mfma_f32_16x16x32_bf16 v[148:151], v[196:199], v[28:31], v[148:151]
    ds_read_b64_tr_b16 v[216:217], v237 offset:45056
    v_mfma_f32_16x16x32_bf16 v[156:159], v[196:199], v[32:35], v[156:159]
    ds_read_b64_tr_b16 v[218:219], v237 offset:45568
    s_waitcnt lgkmcnt(8)
    v_mfma_f32_16x16x32_bf16 v[152:155], v[200:203], v[28:31], v[152:155]
    v_add_u32 v236, 4294918144, v236
    v_add_u32 v237, 4294918144, v237
    ds_read_b64_tr_b16 v[196:197], v236 offset:0
    v_mfma_f32_16x16x32_bf16 v[160:163], v[200:203], v[32:35], v[160:163]
    ds_read_b64_tr_b16 v[198:199], v236 offset:512
    v_mul_f32 v186, v186, v170
    v_mul_f32 v187, v187, v171
    s_waitcnt lgkmcnt(8)
    v_mfma_f32_16x16x32_bf16 v[148:151], v[204:207], v[36:39], v[148:151]
    ds_read_b64_tr_b16 v[200:201], v237 offset:0
    v_mfma_f32_16x16x32_bf16 v[156:159], v[204:207], v[40:43], v[156:159]
    ds_read_b64_tr_b16 v[202:203], v237 offset:512
    v_cvt_pk_bf16_f32 v228, v180, v181
    v_cvt_pk_bf16_f32 v229, v182, v183
    s_waitcnt lgkmcnt(8)
    v_mfma_f32_16x16x32_bf16 v[152:155], v[208:211], v[36:39], v[152:155]
    ds_read_b64_tr_b16 v[204:205], v236 offset:4096
    v_mfma_f32_16x16x32_bf16 v[160:163], v[208:211], v[40:43], v[160:163]
    ds_read_b64_tr_b16 v[206:207], v236 offset:4608
    s_add_u32 m0, s33, 65536
    s_nop 0
    buffer_load_dwordx4 v240, s[16:19], s35 offen  lds
    s_add_u32 s35, s35, s37
    s_waitcnt lgkmcnt(8)
    v_mfma_f32_16x16x32_bf16 v[148:151], v[212:215], v[44:47], v[148:151]
    ds_read_b64_tr_b16 v[208:209], v237 offset:4096
    v_mfma_f32_16x16x32_bf16 v[156:159], v[212:215], v[48:51], v[156:159]
    ds_read_b64_tr_b16 v[210:211], v237 offset:4608
    v_cvt_pk_bf16_f32 v230, v184, v185
    v_cvt_pk_bf16_f32 v231, v186, v187
    s_waitcnt lgkmcnt(8)
    v_mfma_f32_16x16x32_bf16 v[152:155], v[216:219], v[44:47], v[152:155]
    ds_read_b64_tr_b16 v[212:213], v236 offset:8192
    v_mfma_f32_16x16x32_bf16 v[160:163], v[216:219], v[48:51], v[160:163]
    ds_read_b64_tr_b16 v[214:215], v236 offset:8704
    buffer_store_dwordx4 v[228:231], v243, s[24:27], s43 offen sc1
    s_waitcnt lgkmcnt(8)
    v_mfma_f32_16x16x32_bf16 v[148:151], v[196:199], v[52:55], v[148:151]
    s_waitcnt vmcnt(10)
    s_barrier
    ds_read_b64_tr_b16 v[216:217], v237 offset:8192
    v_mfma_f32_16x16x32_bf16 v[156:159], v[196:199], v[56:59], v[156:159]
    ds_read_b64_tr_b16 v[218:219], v237 offset:8704
    v_mul_f32 v188, v188, v172
    v_mul_f32 v189, v189, v173
    s_add_u32 s40, s40, 128
    s_mov_b32 s34, s40
    s_cmp_gt_u32 s46, 1
    s_cselect_b32 s14, s14, 0
    s_waitcnt lgkmcnt(8)
    v_mfma_f32_16x16x32_bf16 v[152:155], v[200:203], v[52:55], v[152:155]
    ds_read_b64_tr_b16 v[196:197], v236 offset:12288
    v_mfma_f32_16x16x32_bf16 v[160:163], v[200:203], v[56:59], v[160:163]
    ds_read_b64_tr_b16 v[198:199], v236 offset:12800
    s_add_u32 m0, s33, 73728
    s_nop 0
    buffer_load_dwordx4 v239, s[12:15], s34 offen  lds
    s_add_u32 s34, s34, s36
    s_waitcnt lgkmcnt(8)
    v_mfma_f32_16x16x32_bf16 v[148:151], v[204:207], v[60:63], v[148:151]
    ds_read_b64_tr_b16 v[200:201], v237 offset:12288
    v_mfma_f32_16x16x32_bf16 v[156:159], v[204:207], v[64:67], v[156:159]
    ds_read_b64_tr_b16 v[202:203], v237 offset:12800
    v_mul_f32 v190, v190, v174
    v_mul_f32 v191, v191, v175
    s_waitcnt lgkmcnt(8)
    v_mfma_f32_16x16x32_bf16 v[152:155], v[208:211], v[60:63], v[152:155]
    ds_read_b64_tr_b16 v[204:205], v236 offset:16384
    v_mfma_f32_16x16x32_bf16 v[160:163], v[208:211], v[64:67], v[160:163]
    ds_read_b64_tr_b16 v[206:207], v236 offset:16896
    v_mul_f32 v192, v192, v176
    v_mul_f32 v193, v193, v177
    s_waitcnt lgkmcnt(8)
    v_mfma_f32_16x16x32_bf16 v[148:151], v[212:215], v[68:71], v[148:151]
    ds_read_b64_tr_b16 v[208:209], v237 offset:16384
    v_mfma_f32_16x16x32_bf16 v[156:159], v[212:215], v[72:75], v[156:159]
    ds_read_b64_tr_b16 v[210:211], v237 offset:16896
    s_waitcnt lgkmcnt(8)
    v_mfma_f32_16x16x32_bf16 v[152:155], v[216:219], v[68:71], v[152:155]
    ds_read_b64_tr_b16 v[212:213], v236 offset:20480
    v_mfma_f32_16x16x32_bf16 v[160:163], v[216:219], v[72:75], v[160:163]
    ds_read_b64_tr_b16 v[214:215], v236 offset:20992
    v_mul_f32 v194, v194, v178
    v_mul_f32 v195, v195, v179
    s_add_u32 m0, s33, 81920
    s_nop 0
    buffer_load_dwordx4 v239, s[12:15], s34 offen  lds
    s_add_u32 s34, s34, s36
    s_waitcnt lgkmcnt(8)
    v_mfma_f32_16x16x32_bf16 v[148:151], v[196:199], v[76:79], v[148:151]
    ds_read_b64_tr_b16 v[216:217], v237 offset:20480
    v_mfma_f32_16x16x32_bf16 v[156:159], v[196:199], v[80:83], v[156:159]
    ds_read_b64_tr_b16 v[218:219], v237 offset:20992
    v_cvt_pk_bf16_f32 v232, v188, v189
    v_cvt_pk_bf16_f32 v233, v190, v191
    s_waitcnt lgkmcnt(8)
    v_mfma_f32_16x16x32_bf16 v[152:155], v[200:203], v[76:79], v[152:155]
    ds_read_b64_tr_b16 v[196:197], v236 offset:24576
    v_mfma_f32_16x16x32_bf16 v[160:163], v[200:203], v[80:83], v[160:163]
    ds_read_b64_tr_b16 v[198:199], v236 offset:25088
    v_cvt_pk_bf16_f32 v234, v192, v193
    v_cvt_pk_bf16_f32 v235, v194, v195
    s_waitcnt lgkmcnt(8)
    v_mfma_f32_16x16x32_bf16 v[148:151], v[204:207], v[84:87], v[148:151]
    ds_read_b64_tr_b16 v[200:201], v237 offset:24576
    v_mfma_f32_16x16x32_bf16 v[156:159], v[204:207], v[88:91], v[156:159]
    ds_read_b64_tr_b16 v[202:203], v237 offset:25088
    s_waitcnt lgkmcnt(8)
    v_mfma_f32_16x16x32_bf16 v[152:155], v[208:211], v[84:87], v[152:155]
    ds_read_b64_tr_b16 v[204:205], v236 offset:28672
    v_mfma_f32_16x16x32_bf16 v[160:163], v[208:211], v[88:91], v[160:163]
    ds_read_b64_tr_b16 v[206:207], v236 offset:29184
    buffer_store_dwordx4 v[232:235], v244, s[24:27], s43 offen sc1
    s_add_u32 m0, s33, 90112
    s_nop 0
    buffer_load_dwordx4 v239, s[12:15], s34 offen  lds
    s_add_u32 s34, s34, s36
    s_waitcnt lgkmcnt(8)
    v_mfma_f32_16x16x32_bf16 v[148:151], v[212:215], v[92:95], v[148:151]
    ds_read_b64_tr_b16 v[208:209], v237 offset:28672
    v_mfma_f32_16x16x32_bf16 v[156:159], v[212:215], v[96:99], v[156:159]
    ds_read_b64_tr_b16 v[210:211], v237 offset:29184
    s_add_u32 s43, s43, 2048
    s_mov_b32 s26, 67108864
    s_waitcnt lgkmcnt(8)
    v_mfma_f32_16x16x32_bf16 v[152:155], v[216:219], v[92:95], v[152:155]
    ds_read_b64_tr_b16 v[212:213], v236 offset:32768
    v_mfma_f32_16x16x32_bf16 v[160:163], v[216:219], v[96:99], v[160:163]
    ds_read_b64_tr_b16 v[214:215], v236 offset:33280
    s_waitcnt lgkmcnt(8)
    v_mfma_f32_16x16x32_bf16 v[148:151], v[196:199], v[100:103], v[148:151]
    s_waitcnt vmcnt(11)
    s_barrier
    ds_read_b64_tr_b16 v[216:217], v237 offset:32768
    v_mfma_f32_16x16x32_bf16 v[156:159], v[196:199], v[104:107], v[156:159]
    ds_read_b64_tr_b16 v[218:219], v237 offset:33280
    s_waitcnt lgkmcnt(8)
    v_mfma_f32_16x16x32_bf16 v[152:155], v[200:203], v[100:103], v[152:155]
    ds_read_b64_tr_b16 v[196:197], v236 offset:36864
    v_mfma_f32_16x16x32_bf16 v[160:163], v[200:203], v[104:107], v[160:163]
    ds_read_b64_tr_b16 v[198:199], v236 offset:37376
    s_add_u32 m0, s33, 0
    s_nop 0
    buffer_load_dwordx4 v239, s[12:15], s34 offen  lds
    s_add_u32 s34, s34, s36
    s_waitcnt lgkmcnt(8)
    v_mfma_f32_16x16x32_bf16 v[148:151], v[204:207], v[108:111], v[148:151]
    ds_read_b64_tr_b16 v[200:201], v237 offset:36864
    v_mfma_f32_16x16x32_bf16 v[156:159], v[204:207], v[112:115], v[156:159]
    ds_read_b64_tr_b16 v[202:203], v237 offset:37376
    s_waitcnt lgkmcnt(8)
    v_mfma_f32_16x16x32_bf16 v[152:155], v[208:211], v[108:111], v[152:155]
    ds_read_b64_tr_b16 v[204:205], v236 offset:40960
    v_mfma_f32_16x16x32_bf16 v[160:163], v[208:211], v[112:115], v[160:163]
    ds_read_b64_tr_b16 v[206:207], v236 offset:41472
    s_waitcnt lgkmcnt(8)
    v_mfma_f32_16x16x32_bf16 v[148:151], v[212:215], v[116:119], v[148:151]
    ds_read_b64_tr_b16 v[208:209], v237 offset:40960
    v_mfma_f32_16x16x32_bf16 v[156:159], v[212:215], v[120:123], v[156:159]
    ds_read_b64_tr_b16 v[210:211], v237 offset:41472
    s_waitcnt lgkmcnt(8)
    v_mfma_f32_16x16x32_bf16 v[152:155], v[216:219], v[116:119], v[152:155]
    ds_read_b64_tr_b16 v[212:213], v236 offset:45056
    v_mfma_f32_16x16x32_bf16 v[160:163], v[216:219], v[120:123], v[160:163]
    ds_read_b64_tr_b16 v[214:215], v236 offset:45568
    s_add_u32 m0, s33, 8192
    s_nop 0
    buffer_load_dwordx4 v239, s[12:15], s34 offen  lds
    s_add_u32 s34, s34, s36
    s_waitcnt lgkmcnt(8)
    v_mfma_f32_16x16x32_bf16 v[148:151], v[196:199], v[124:127], v[148:151]
    ds_read_b64_tr_b16 v[216:217], v237 offset:45056
    v_mfma_f32_16x16x32_bf16 v[156:159], v[196:199], v[128:131], v[156:159]
    ds_read_b64_tr_b16 v[218:219], v237 offset:45568
    s_waitcnt lgkmcnt(8)
    v_mfma_f32_16x16x32_bf16 v[152:155], v[200:203], v[124:127], v[152:155]
    v_add_u32 v236, 98304, v236
    v_add_u32 v237, 98304, v237
    ds_read_b64_tr_b16 v[196:197], v236 offset:0
    v_mfma_f32_16x16x32_bf16 v[160:163], v[200:203], v[128:131], v[160:163]
    ds_read_b64_tr_b16 v[198:199], v236 offset:512
    s_waitcnt lgkmcnt(8)
    v_mfma_f32_16x16x32_bf16 v[148:151], v[204:207], v[132:135], v[148:151]
    ds_read_b64_tr_b16 v[200:201], v237 offset:0
    v_mfma_f32_16x16x32_bf16 v[156:159], v[204:207], v[136:139], v[156:159]
    ds_read_b64_tr_b16 v[202:203], v237 offset:512
    s_waitcnt lgkmcnt(8)
    v_mfma_f32_16x16x32_bf16 v[152:155], v[208:211], v[132:135], v[152:155]
    ds_read_b64_tr_b16 v[204:205], v236 offset:4096
    v_mfma_f32_16x16x32_bf16 v[160:163], v[208:211], v[136:139], v[160:163]
    ds_read_b64_tr_b16 v[206:207], v236 offset:4608
    s_add_u32 m0, s33, 16384
    s_nop 0
    buffer_load_dwordx4 v239, s[12:15], s34 offen  lds
    s_add_u32 s34, s34, s36
    s_waitcnt lgkmcnt(8)
    v_mfma_f32_16x16x32_bf16 v[148:151], v[212:215], v[140:143], v[148:151]
    ds_read_b64_tr_b16 v[208:209], v237 offset:4096
    v_mfma_f32_16x16x32_bf16 v[156:159], v[212:215], v[144:147], v[156:159]
    ds_read_b64_tr_b16 v[210:211], v237 offset:4608
    s_waitcnt lgkmcnt(8)
    v_mfma_f32_16x16x32_bf16 v[152:155], v[216:219], v[140:143], v[152:155]
    ds_read_b64_tr_b16 v[212:213], v236 offset:8192
    v_mfma_f32_16x16x32_bf16 v[160:163], v[216:219], v[144:147], v[160:163]
    ds_read_b64_tr_b16 v[214:215], v236 offset:8704
    s_waitcnt lgkmcnt(8)
    v_mfma_f32_16x16x32_bf16 v[164:167], v[196:199], v[4:7], 0
    s_waitcnt vmcnt(11)
    s_barrier
    ds_read_b64_tr_b16 v[216:217], v237 offset:8192
    v_mfma_f32_16x16x32_bf16 v[172:175], v[196:199], v[8:11], 0
    ds_read_b64_tr_b16 v[218:219], v237 offset:8704
    s_waitcnt lgkmcnt(8)
    v_mfma_f32_16x16x32_bf16 v[168:171], v[200:203], v[4:7], 0
    ds_read_b64_tr_b16 v[196:197], v236 offset:12288
    v_mfma_f32_16x16x32_bf16 v[176:179], v[200:203], v[8:11], 0
    ds_read_b64_tr_b16 v[198:199], v236 offset:12800
    s_add_u32 m0, s33, 24576
    s_nop 0
    buffer_load_dwordx4 v239, s[12:15], s34 offen  lds
    s_add_u32 s34, s34, s36
    s_waitcnt lgkmcnt(8)
    v_mfma_f32_16x16x32_bf16 v[164:167], v[204:207], v[12:15], v[164:167]
    ds_read_b64_tr_b16 v[200:201], v237 offset:12288
    v_mfma_f32_16x16x32_bf16 v[172:175], v[204:207], v[16:19], v[172:175]
    ds_read_b64_tr_b16 v[202:203], v237 offset:12800
    s_cmp_lg_u32 s46, s92
    s_cbranch_scc1 K1_NE
    v_mov_b32 v250, 1
    s_mov_b64 exec, 1
    buffer_atomic_add v250, v254, s[4:7], 0 offen sc1
    s_mov_b64 exec, -1
K1_NE:
    s_waitcnt lgkmcnt(8)
    v_mfma_f32_16x16x32_bf16 v[168:171], v[208:211], v[12:15], v[168:171]
    ds_read_b64_tr_b16 v[204:205], v236 offset:16384
    v_mfma_f32_16x16x32_bf16 v[176:179], v[208:211], v[16:19], v[176:179]
    ds_read_b64_tr_b16 v[206:207], v236 offset:16896
    v_mul_f32 v180, v148, v148
    v_mul_f32 v181, v149, v149
    v_mul_f32 v182, v150, v150
    v_mul_f32 v183, v151, v151
    s_waitcnt lgkmcnt(8)
    v_mfma_f32_16x16x32_bf16 v[164:167], v[212:215], v[20:23], v[164:167]
    ds_read_b64_tr_b16 v[208:209], v237 offset:16384
    v_mfma_f32_16x16x32_bf16 v[172:175], v[212:215], v[24:27], v[172:175]
    ds_read_b64_tr_b16 v[210:211], v237 offset:16896
    v_fmaak_f32 v180, v180, v247, 0xc0135761
    v_fmaak_f32 v181, v181, v247, 0xc0135761
    v_fmaak_f32 v182, v182, v247, 0xc0135761
    v_fmaak_f32 v183, v183, v247, 0xc0135761
    s_waitcnt lgkmcnt(8)
    v_mfma_f32_16x16x32_bf16 v[168:171], v[216:219], v[20:23], v[168:171]
    ds_read_b64_tr_b16 v[212:213], v236 offset:20480
    v_mfma_f32_16x16x32_bf16 v[176:179], v[216:219], v[24:27], v[176:179]
    ds_read_b64_tr_b16 v[214:215], v236 offset:20992
    v_mul_f32 v180, v148, v180
    v_mul_f32 v181, v149, v181
    v_mul_f32 v182, v150, v182
    s_add_u32 m0, s33, 32768
    s_nop 0
    buffer_load_dwordx4 v239, s[12:15], s34 offen  lds
    s_add_u32 s34, s34, s36
    s_waitcnt lgkmcnt(8)
    v_mfma_f32_16x16x32_bf16 v[164:167], v[196:199], v[28:31], v[164:167]
    ds_read_b64_tr_b16 v[216:217], v237 offset:20480
    v_mfma_f32_16x16x32_bf16 v[172:175], v[196:199], v[32:35], v[172:175]
    ds_read_b64_tr_b16 v[218:219], v237 offset:20992
    v_mul_f32 v183, v151, v183
    v_exp_f32 v180, v180
    v_exp_f32 v181, v181
    v_exp_f32 v182, v182
    s_waitcnt lgkmcnt(8)
    v_mfma_f32_16x16x32_bf16 v[168:171], v[200:203], v[28:31], v[168:171]
    ds_read_b64_tr_b16 v[196:197], v236 offset:24576
    v_mfma_f32_16x16x32_bf16 v[176:179], v[200:203], v[32:35], v[176:179]
    ds_read_b64_tr_b16 v[198:199], v236 offset:25088
    v_exp_f32 v183, v183
    v_add_f32 v180, 1.0, v180
    v_add_f32 v181, 1.0, v181
    v_add_f32 v182, 1.0, v182
    s_waitcnt lgkmcnt(8)
    v_mfma_f32_16x16x32_bf16 v[164:167], v[204:207], v[36:39], v[164:167]
    ds_read_b64_tr_b16 v[200:201], v237 offset:24576
    v_mfma_f32_16x16x32_bf16 v[172:175], v[204:207], v[40:43], v[172:175]
    ds_read_b64_tr_b16 v[202:203], v237 offset:25088
    v_add_f32 v183, 1.0, v183
    v_rcp_f32 v180, v180
    v_rcp_f32 v181, v181
    s_waitcnt lgkmcnt(8)
    v_mfma_f32_16x16x32_bf16 v[168:171], v[208:211], v[36:39], v[168:171]
    ds_read_b64_tr_b16 v[204:205], v236 offset:28672
    v_mfma_f32_16x16x32_bf16 v[176:179], v[208:211], v[40:43], v[176:179]
    ds_read_b64_tr_b16 v[206:207], v236 offset:29184
    v_rcp_f32 v182, v182
    v_rcp_f32 v183, v183
    v_mul_f32 v180, v148, v180
    v_mul_f32 v181, v149, v181
    s_add_u32 m0, s33, 40960
    s_nop 0
    buffer_load_dwordx4 v239, s[12:15], s34 offen  lds
    s_add_u32 s34, s34, s36
    s_waitcnt lgkmcnt(8)
    v_mfma_f32_16x16x32_bf16 v[164:167], v[212:215], v[44:47], v[164:167]
    ds_read_b64_tr_b16 v[208:209], v237 offset:28672
    v_mfma_f32_16x16x32_bf16 v[172:175], v[212:215], v[48:51], v[172:175]
    ds_read_b64_tr_b16 v[210:211], v237 offset:29184
    v_mul_f32 v182, v150, v182
    v_mul_f32 v183, v151, v183
    v_mul_f32 v184, v152, v152
    s_waitcnt lgkmcnt(8)
    v_mfma_f32_16x16x32_bf16 v[168:171], v[216:219], v[44:47], v[168:171]
    ds_read_b64_tr_b16 v[212:213], v236 offset:32768
    v_mfma_f32_16x16x32_bf16 v[176:179], v[216:219], v[48:51], v[176:179]
    ds_read_b64_tr_b16 v[214:215], v236 offset:33280
    v_mul_f32 v185, v153, v153
    v_mul_f32 v186, v154, v154
    v_mul_f32 v187, v155, v155
    v_fmaak_f32 v184, v184, v247, 0xc0135761
    s_waitcnt lgkmcnt(8)
    v_mfma_f32_16x16x32_bf16 v[164:167], v[196:199], v[52:55], v[164:167]
    s_waitcnt vmcnt(11)
    s_barrier
    ds_read_b64_tr_b16 v[216:217], v237 offset:32768
    v_mfma_f32_16x16x32_bf16 v[172:175], v[196:199], v[56:59], v[172:175]
    ds_read_b64_tr_b16 v[218:219], v237 offset:33280
    v_fmaak_f32 v185, v185, v247, 0xc0135761
    v_fmaak_f32 v186, v186, v247, 0xc0135761
    v_fmaak_f32 v187, v187, v247, 0xc0135761
    v_mul_f32 v184, v152, v184
    s_mov_b32 s35, s40
    s_cmp_gt_u32 s46, 1
    s_cselect_b32 s18, s18, 0
    s_waitcnt lgkmcnt(8)
    v_mfma_f32_16x16x32_bf16 v[168:171], v[200:203], v[52:55], v[168:171]
    ds_read_b64_tr_b16 v[196:197], v236 offset:36864
    v_mfma_f32_16x16x32_bf16 v[176:179], v[200:203], v[56:59], v[176:179]
    ds_read_b64_tr_b16 v[198:199], v236 offset:37376
    v_mul_f32 v185, v153, v185
    v_mul_f32 v186, v154, v186
    v_mul_f32 v187, v155, v187
    s_add_u32 m0, s33, 98304
    s_nop 0
    buffer_load_dwordx4 v240, s[16:19], s35 offen  lds
    s_add_u32 s35, s35, s37
    s_cmp_ge_u32 s61, 2592
    s_cbranch_scc1 K1_G2
    ds_read_b64_tr_b16 v[220:221], v238
    ds_read_b64_tr_b16 v[222:223], v238 offset:1024
    ds_read_b64_tr_b16 v[224:225], v238 offset:8
    ds_read_b64_tr_b16 v[226:227], v238 offset:1032
K1_G2:
    s_waitcnt lgkmcnt(8)
    v_mfma_f32_16x16x32_bf16 v[164:167], v[204:207], v[60:63], v[164:167]
    ds_read_b64_tr_b16 v[200:201], v237 offset:36864
    v_mfma_f32_16x16x32_bf16 v[172:175], v[204:207], v[64:67], v[172:175]
    ds_read_b64_tr_b16 v[202:203], v237 offset:37376
    v_exp_f32 v184, v184
    v_exp_f32 v185, v185
    v_exp_f32 v186, v186
    v_exp_f32 v187, v187
    s_waitcnt lgkmcnt(8)
    v_mfma_f32_16x16x32_bf16 v[168:171], v[208:211], v[60:63], v[168:171]
    ds_read_b64_tr_b16 v[204:205], v236 offset:40960
    v_mfma_f32_16x16x32_bf16 v[176:179], v[208:211], v[64:67], v[176:179]
    ds_read_b64_tr_b16 v[206:207], v236 offset:41472
    v_add_f32 v184, 1.0, v184
    v_add_f32 v185, 1.0, v185
    v_add_f32 v186, 1.0, v186
    s_waitcnt lgkmcnt(8)
    v_mfma_f32_16x16x32_bf16 v[164:167], v[212:215], v[68:71], v[164:167]
    ds_read_b64_tr_b16 v[208:209], v237 offset:40960
    v_mfma_f32_16x16x32_bf16 v[172:175], v[212:215], v[72:75], v[172:175]
    ds_read_b64_tr_b16 v[210:211], v237 offset:41472
    v_add_f32 v187, 1.0, v187
    v_rcp_f32 v184, v184
    v_rcp_f32 v185, v185
    v_rcp_f32 v186, v186
    s_waitcnt lgkmcnt(8)
    v_mfma_f32_16x16x32_bf16 v[168:171], v[216:219], v[68:71], v[168:171]
    ds_read_b64_tr_b16 v[212:213], v236 offset:45056
    v_mfma_f32_16x16x32_bf16 v[176:179], v[216:219], v[72:75], v[176:179]
    ds_read_b64_tr_b16 v[214:215], v236 offset:45568
    v_rcp_f32 v187, v187
    v_mul_f32 v184, v152, v184
    v_mul_f32 v185, v153, v185
    v_mul_f32 v186, v154, v186
    s_add_u32 m0, s33, 106496
    s_nop 0
    buffer_load_dwordx4 v240, s[16:19], s35 offen  lds
    s_add_u32 s35, s35, s37
    s_waitcnt lgkmcnt(8)
    v_mfma_f32_16x16x32_bf16 v[164:167], v[196:199], v[76:79], v[164:167]
    ds_read_b64_tr_b16 v[216:217], v237 offset:45056
    v_mfma_f32_16x16x32_bf16 v[172:175], v[196:199], v[80:83], v[172:175]
    ds_read_b64_tr_b16 v[218:219], v237 offset:45568
    v_mul_f32 v187, v155, v187
    v_mul_f32 v188, v156, v156
    v_mul_f32 v189, v157, v157
    s_cmp_ge_u32 s61, 2592
    s_cbranch_scc1 K1_G3
    s_lshl_b32 s88, s61, 11
    s_add_u32 s88, s88, 29360128
    s_waitcnt lgkmcnt(12)
    buffer_store_dwordx4 v[220:223], v243, s[20:23], s88 offen sc1
    s_waitcnt lgkmcnt(10)
    buffer_store_dwordx4 v[224:227], v243, s[20:23], s88 offen offset:1024 sc1
    s_mov_b32 s61, s89
    s_mov_b32 s89, 4000
K1_G3:
    s_waitcnt lgkmcnt(8)
    v_mfma_f32_16x16x32_bf16 v[168:171], v[200:203], v[76:79], v[168:171]
    v_add_u32 v236, 4294918144, v236
    v_add_u32 v237, 4294918144, v237
    ds_read_b64_tr_b16 v[196:197], v236 offset:0
    v_mfma_f32_16x16x32_bf16 v[176:179], v[200:203], v[80:83], v[176:179]
    ds_read_b64_tr_b16 v[198:199], v236 offset:512
    v_mul_f32 v190, v158, v158
    v_mul_f32 v191, v159, v159
    v_fmaak_f32 v188, v188, v247, 0xc0135761
    v_fmaak_f32 v189, v189, v247, 0xc0135761
    s_waitcnt lgkmcnt(8)
    v_mfma_f32_16x16x32_bf16 v[164:167], v[204:207], v[84:87], v[164:167]
    ds_read_b64_tr_b16 v[200:201], v237 offset:0
    v_mfma_f32_16x16x32_bf16 v[172:175], v[204:207], v[88:91], v[172:175]
    ds_read_b64_tr_b16 v[202:203], v237 offset:512
    v_fmaak_f32 v190, v190, v247, 0xc0135761
    v_fmaak_f32 v191, v191, v247, 0xc0135761
    v_mul_f32 v188, v156, v188
    v_mul_f32 v189, v157, v189
    s_lshl_b32 s41, s28, 4
    s_add_u32 s41, s41, s46
    s_cmp_lg_u32 s41, 1
    s_cbranch_scc1 K1_NP
    buffer_load_dword v253, v254, s[4:7], 0 offen sc1
K1_NP:
    s_waitcnt lgkmcnt(8)
    v_mfma_f32_16x16x32_bf16 v[168:171], v[208:211], v[84:87], v[168:171]
    ds_read_b64_tr_b16 v[204:205], v236 offset:4096
    v_mfma_f32_16x16x32_bf16 v[176:179], v[208:211], v[88:91], v[176:179]
    ds_read_b64_tr_b16 v[206:207], v236 offset:4608
    v_mul_f32 v190, v158, v190
    v_mul_f32 v191, v159, v191
    v_exp_f32 v188, v188
    s_add_u32 m0, s33, 114688
    s_nop 0
    buffer_load_dwordx4 v240, s[16:19], s35 offen  lds
    s_add_u32 s35, s35, s37
    s_waitcnt lgkmcnt(8)
    v_mfma_f32_16x16x32_bf16 v[164:167], v[212:215], v[92:95], v[164:167]
    ds_read_b64_tr_b16 v[208:209], v237 offset:4096
    v_mfma_f32_16x16x32_bf16 v[172:175], v[212:215], v[96:99], v[172:175]
    ds_read_b64_tr_b16 v[210:211], v237 offset:4608
    v_exp_f32 v189, v189
    v_exp_f32 v190, v190
    v_exp_f32 v191, v191
    v_add_f32 v188, 1.0, v188
    s_waitcnt lgkmcnt(8)
    v_mfma_f32_16x16x32_bf16 v[168:171], v[216:219], v[92:95], v[168:171]
    ds_read_b64_tr_b16 v[212:213], v236 offset:8192
    v_mfma_f32_16x16x32_bf16 v[176:179], v[216:219], v[96:99], v[176:179]
    ds_read_b64_tr_b16 v[214:215], v236 offset:8704
    v_add_f32 v189, 1.0, v189
    v_add_f32 v190, 1.0, v190
    v_add_f32 v191, 1.0, v191
    s_waitcnt lgkmcnt(8)
    v_mfma_f32_16x16x32_bf16 v[164:167], v[196:199], v[100:103], v[164:167]
    s_waitcnt vmcnt(9)
    s_barrier
    ds_read_b64_tr_b16 v[216:217], v237 offset:8192
    v_mfma_f32_16x16x32_bf16 v[172:175], v[196:199], v[104:107], v[172:175]
    ds_read_b64_tr_b16 v[218:219], v237 offset:8704
    v_rcp_f32 v188, v188
    v_rcp_f32 v189, v189
    v_rcp_f32 v190, v190
    v_rcp_f32 v191, v191
    s_waitcnt lgkmcnt(8)
    v_mfma_f32_16x16x32_bf16 v[168:171], v[200:203], v[100:103], v[168:171]
    ds_read_b64_tr_b16 v[196:197], v236 offset:12288
    v_mfma_f32_16x16x32_bf16 v[176:179], v[200:203], v[104:107], v[176:179]
    ds_read_b64_tr_b16 v[198:199], v236 offset:12800
    v_mul_f32 v188, v156, v188
    v_mul_f32 v189, v157, v189
    v_mul_f32 v190, v158, v190
    v_mul_f32 v191, v159, v191
    s_add_u32 m0, s33, 122880
    s_nop 0
    buffer_load_dwordx4 v240, s[16:19], s35 offen  lds
    s_add_u32 s35, s35, s37
    s_waitcnt lgkmcnt(8)
    v_mfma_f32_16x16x32_bf16 v[164:167], v[204:207], v[108:111], v[164:167]
    ds_read_b64_tr_b16 v[200:201], v237 offset:12288
    v_mfma_f32_16x16x32_bf16 v[172:175], v[204:207], v[112:115], v[172:175]
    ds_read_b64_tr_b16 v[202:203], v237 offset:12800
    v_mul_f32 v192, v160, v160
    v_mul_f32 v193, v161, v161
    v_mul_f32 v194, v162, v162
    s_waitcnt lgkmcnt(8)
    v_mfma_f32_16x16x32_bf16 v[168:171], v[208:211], v[108:111], v[168:171]
    ds_read_b64_tr_b16 v[204:205], v236 offset:16384
    v_mfma_f32_16x16x32_bf16 v[176:179], v[208:211], v[112:115], v[176:179]
    ds_read_b64_tr_b16 v[206:207], v236 offset:16896
    v_mul_f32 v195, v163, v163
    v_fmaak_f32 v192, v192, v247, 0xc0135761
    v_fmaak_f32 v193, v193, v247, 0xc0135761
    v_fmaak_f32 v194, v194, v247, 0xc0135761
    s_waitcnt lgkmcnt(8)
    v_mfma_f32_16x16x32_bf16 v[164:167], v[212:215], v[116:119], v[164:167]
    ds_read_b64_tr_b16 v[208:209], v237 offset:16384
    v_mfma_f32_16x16x32_bf16 v[172:175], v[212:215], v[120:123], v[172:175]
    ds_read_b64_tr_b16 v[210:211], v237 offset:16896
    v_fmaak_f32 v195, v195, v247, 0xc0135761
    v_mul_f32 v192, v160, v192
    v_mul_f32 v193, v161, v193
    s_waitcnt lgkmcnt(8)
    v_mfma_f32_16x16x32_bf16 v[168:171], v[216:219], v[116:119], v[168:171]
    ds_read_b64_tr_b16 v[212:213], v236 offset:20480
    v_mfma_f32_16x16x32_bf16 v[176:179], v[216:219], v[120:123], v[176:179]
    ds_read_b64_tr_b16 v[214:215], v236 offset:20992
    v_mul_f32 v194, v162, v194
    v_mul_f32 v195, v163, v195
    v_exp_f32 v192, v192
    v_exp_f32 v193, v193
    s_add_u32 m0, s33, 131072
    s_nop 0
    buffer_load_dwordx4 v240, s[16:19], s35 offen  lds
    s_add_u32 s35, s35, s37
    s_waitcnt lgkmcnt(8)
    v_mfma_f32_16x16x32_bf16 v[164:167], v[196:199], v[124:127], v[164:167]
    ds_read_b64_tr_b16 v[216:217], v237 offset:20480
    v_mfma_f32_16x16x32_bf16 v[172:175], v[196:199], v[128:131], v[172:175]
    ds_read_b64_tr_b16 v[218:219], v237 offset:20992
    v_exp_f32 v194, v194
    v_exp_f32 v195, v195
    v_add_f32 v192, 1.0, v192
    v_add_f32 v193, 1.0, v193
    s_waitcnt lgkmcnt(8)
    v_mfma_f32_16x16x32_bf16 v[168:171], v[200:203], v[124:127], v[168:171]
    ds_read_b64_tr_b16 v[196:197], v236 offset:24576
    v_mfma_f32_16x16x32_bf16 v[176:179], v[200:203], v[128:131], v[176:179]
    ds_read_b64_tr_b16 v[198:199], v236 offset:25088
    v_add_f32 v194, 1.0, v194
    v_add_f32 v195, 1.0, v195
    v_rcp_f32 v192, v192
    s_waitcnt lgkmcnt(8)
    v_mfma_f32_16x16x32_bf16 v[164:167], v[204:207], v[132:135], v[164:167]
    ds_read_b64_tr_b16 v[200:201], v237 offset:24576
    v_mfma_f32_16x16x32_bf16 v[172:175], v[204:207], v[136:139], v[172:175]
    ds_read_b64_tr_b16 v[202:203], v237 offset:25088
    v_rcp_f32 v193, v193
    v_rcp_f32 v194, v194
    v_rcp_f32 v195, v195
    v_mul_f32 v192, v160, v192
    s_waitcnt lgkmcnt(8)
    v_mfma_f32_16x16x32_bf16 v[168:171], v[208:211], v[132:135], v[168:171]
    ds_read_b64_tr_b16 v[204:205], v236 offset:28672
    v_mfma_f32_16x16x32_bf16 v[176:179], v[208:211], v[136:139], v[176:179]
    ds_read_b64_tr_b16 v[206:207], v236 offset:29184
    v_mul_f32 v193, v161, v193
    v_mul_f32 v194, v162, v194
    v_mul_f32 v195, v163, v195
    s_add_u32 m0, s33, 139264
    s_nop 0
    buffer_load_dwordx4 v240, s[16:19], s35 offen  lds
    s_add_u32 s35, s35, s37
    s_waitcnt lgkmcnt(8)
    v_mfma_f32_16x16x32_bf16 v[164:167], v[212:215], v[140:143], v[164:167]
    ds_read_b64_tr_b16 v[208:209], v237 offset:28672
    v_mfma_f32_16x16x32_bf16 v[172:175], v[212:215], v[144:147], v[172:175]
    ds_read_b64_tr_b16 v[210:211], v237 offset:29184
    s_waitcnt lgkmcnt(8)
    v_mfma_f32_16x16x32_bf16 v[168:171], v[216:219], v[140:143], v[168:171]
    ds_read_b64_tr_b16 v[212:213], v236 offset:32768
    v_mfma_f32_16x16x32_bf16 v[176:179], v[216:219], v[144:147], v[176:179]
    ds_read_b64_tr_b16 v[214:215], v236 offset:33280
    s_sub_u32 s46, s46, 1
    s_cmp_lg_u32 s46, 0
    s_cbranch_scc1 K1_LOOP
    s_waitcnt vmcnt(0) lgkmcnt(0)
    s_cmp_lg_u32 s28, 0
    s_cbranch_scc1 K1_EOK
    s_mov_b32 s42, 0
K1_EP:
    v_readfirstlane_b32 s41, v253
    s_add_u32 s42, s42, 1
    s_nop 0
    s_cmp_ge_u32 s41, 256
    s_cbranch_scc1 K1_EOK
    s_cmp_ge_u32 s42, 0x20000
    s_cbranch_scc1 K1_EOK
    buffer_load_dword v253, v254, s[4:7], 0 offen sc1
    s_waitcnt vmcnt(0)
    s_branch K1_EP
K1_EOK:
    s_barrier
    s_nop 3
    v_mul_f32 v180, v180, v164
    v_mul_f32 v181, v181, v165
    v_mul_f32 v182, v182, v166
    v_mul_f32 v183, v183, v167
    v_mul_f32 v184, v184, v168
    v_mul_f32 v185, v185, v169
    v_mul_f32 v186, v186, v170
    v_mul_f32 v187, v187, v171
    v_cvt_pk_bf16_f32 v228, v180, v181
    v_cvt_pk_bf16_f32 v229, v182, v183
    v_cvt_pk_bf16_f32 v230, v184, v185
    v_cvt_pk_bf16_f32 v231, v186, v187
    v_mul_f32 v188, v188, v172
    v_mul_f32 v189, v189, v173
    v_mul_f32 v190, v190, v174
    v_mul_f32 v191, v191, v175
    v_mul_f32 v192, v192, v176
    v_mul_f32 v193, v193, v177
    v_mul_f32 v194, v194, v178
    v_mul_f32 v195, v195, v179
    v_cvt_pk_bf16_f32 v232, v188, v189
    v_cvt_pk_bf16_f32 v233, v190, v191
    v_cvt_pk_bf16_f32 v234, v192, v193
    v_cvt_pk_bf16_f32 v235, v194, v195
    s_mov_b32 s61, s43
    buffer_store_dwordx4 v[228:231], v243, s[20:23], s61 offen sc1
    buffer_store_dwordx4 v[232:235], v244, s[20:23], s61 offen sc1
    s_lshl_b32 s60, s31, 5
    s_add_u32 s60, s60, s32
    s_lshl_b32 s60, s60, 2
    s_add_u32 s60, s60, 54528000
    s_mov_b32 s56, s48
    s_mov_b32 s57, s49
    s_and_b32 s29, s2, 7
    s_lshr_b32 s30, s2, 3
    s_lshl_b32 s34, s29, 2
    s_lshr_b32 s31, s30, 3
    s_add_u32 s34, s34, s31
    s_and_b32 s35, s34, 1
    s_lshr_b32 s31, s34, 1
    s_mul_i32 s31, s31, 9
    s_lshl_b32 s32, s35, 2
    s_add_u32 s31, s31, s32
    s_lshl_b32 s38, s31, 14
    s_add_u32 s36, s38, 2359296
    s_mul_i32 s37, s34, 73728
    s_add_u32 s37, s37, 4718592
    s_lshl_b32 s39, s35, 14
    s_xor_b32 s40, s35, 1
    s_lshl_b32 s40, s40, 16
    s_and_b32 s41, s30, 15
    s_lshl_b32 s41, s41, 1
    s_lshr_b32 s31, s30, 4
    s_or_b32 s41, s41, s31
    s_mov_b32 s41, s30
    v_lshlrev_b32 v1, 4, v0
    s_cmp_ge_u32 s28, 4
    s_cbranch_scc1 P2_GEMM
    s_and_b32 s31, s30, 7
    s_lshl_b32 s42, s31, 3
    s_lshl_b32 s31, s28, 1
    s_add_u32 s42, s42, s31
    v_and_b32 v180, 31, v0
    v_lshrrev_b32 v181, 5, v0
    v_lshlrev_b32 v182, 3, v180
    v_lshl_add_u32 v183, v181, 15, v182
    s_lshl_b32 s31, s42, 8
    s_add_u32 s31, s31, s38
    s_add_u32 s32, s31, s39
    s_add_u32 s33, s32, 16384
    s_add_u32 s31, s31, s40
    buffer_load_dwordx2 v[2:3], v183, s[20:23], s32 offen offset:0 sc1
    buffer_load_dwordx2 v[4:5], v183, s[20:23], s33 offen offset:0 sc1
    buffer_load_dwordx2 v[184:185], v182, s[20:23], s31 offen offset:0 sc1
    buffer_load_dwordx2 v[6:7], v183, s[20:23], s32 offen offset:256 sc1
    buffer_load_dwordx2 v[8:9], v183, s[20:23], s33 offen offset:256 sc1
    buffer_load_dwordx2 v[186:187], v182, s[20:23], s31 offen offset:256 sc1
    v_and_b32 v84, 1, v0
    v_add_u32 v84, -1, v84
    v_and_b32 v84, 0x3f803f80, v84
    v_mov_b32 v85, v84
    v_mov_b32 v86, v84
    v_mov_b32 v87, v84
    s_lshl_b32 s32, s28, 11
    s_add_u32 s32, s32, 155648
    v_add_u32 v188, s32, v1
    ds_write_b128 v188, v[84:87]
    ds_write_b128 v188, v[84:87] offset:1024
    v_add_u32 v176, s39, v183
    v_lshlrev_b32 v177, 3, v0
    v_add_u32 v177, s40, v177
    v_mul_u32_u24 v178, 288, v181
    v_lshl_add_u32 v178, v180, 4, v178
    v_add_u32 v178, 81920, v178
    v_mov_b32 v179, 4608
    v_cmp_gt_u32 vcc, 18, v180
    v_and_b32 v188, 27, v180
    v_cmp_eq_u32 s[46:47], 18, v188
    v_mov_b32 v188, 155664
    v_mov_b32 v189, 155648
    v_cndmask_b32_e64 v188, v188, v189, s[46:47]
    v_cndmask_b32 v178, v188, v178, vcc
    v_cndmask_b32 v179, 0, v179, vcc
    s_cmp_eq_u32 s35, 0
    s_cselect_b32 s31, -1, 0
    s_cselect_b32 s32, 0, -1
    v_cmp_eq_u32 vcc, 0, v181
    v_mov_b32 v84, 0
    v_mov_b32 v85, 0
    v_mov_b32 v86, 0
    v_mov_b32 v87, 0
    v_mov_b32 v88, 0
    v_mov_b32 v89, 0
    v_mov_b32 v90, 0
    v_mov_b32 v91, 0
    v_mov_b32 v92, 0
    v_mov_b32 v93, 0
    v_mov_b32 v94, 0
    v_mov_b32 v95, 0
    v_mov_b32 v96, 0
    v_mov_b32 v97, 0
    v_mov_b32 v98, 0
    v_mov_b32 v99, 0
    v_mov_b32 v100, 0
    v_mov_b32 v101, 0
    v_mov_b32 v102, 0
    v_mov_b32 v103, 0
    v_mov_b32 v104, 0
    v_mov_b32 v105, 0
    v_mov_b32 v106, 0
    v_mov_b32 v107, 0
    v_mov_b32 v108, 0
    v_mov_b32 v109, 0
    v_mov_b32 v110, 0
    v_mov_b32 v111, 0
    v_mov_b32 v112, 0
    v_mov_b32 v113, 0
    v_mov_b32 v114, 0
    v_mov_b32 v115, 0
    v_mov_b32 v116, 0
    v_mov_b32 v168, 0
    v_mov_b32 v117, 0
    v_mov_b32 v169, 0
    v_mov_b32 v118, 0
    v_mov_b32 v170, 0
    v_mov_b32 v119, 0
    v_mov_b32 v171, 0
    v_mov_b32 v120, 0
    v_mov_b32 v172, 0
    v_mov_b32 v121, 0
    v_mov_b32 v173, 0
    v_mov_b32 v122, 0
    v_mov_b32 v174, 0
    v_mov_b32 v123, 0
    v_mov_b32 v175, 0
    s_waitcnt vmcnt(3)
    v_and_b32 v184, s31, v184
    v_and_b32 v185, s32, v185
    v_cndmask_b32 v10, 0, v184, vcc
    v_cndmask_b32 v11, 0, v185, vcc
    v_cndmask_b32_e64 v12, v184, 0, vcc
    v_cndmask_b32_e64 v13, v185, 0, vcc
    s_waitcnt vmcnt(0)
    v_and_b32 v186, s31, v186
    v_and_b32 v187, s32, v187
    v_cndmask_b32 v14, 0, v186, vcc
    v_cndmask_b32 v15, 0, v187, vcc
    v_cndmask_b32_e64 v16, v186, 0, vcc
    v_cndmask_b32_e64 v17, v187, 0, vcc
    s_waitcnt lgkmcnt(0)
    s_barrier
    ds_read_b64 v[124:125], v176 offset:0
    ds_read_b64 v[126:127], v176 offset:16384
    ds_read_b64 v[140:141], v177 offset:0
    ds_read_b128 v[144:147], v178 offset:0
    ds_read_b128 v[148:151], v178 offset:576
    ds_read_b64 v[128:129], v176 offset:256
    ds_read_b64 v[130:131], v176 offset:16640
    s_waitcnt lgkmcnt(5)
    v_mfma_f32_32x32x16_bf16 v[52:67], v[124:127], v[2:5], 0
    v_mfma_f32_32x32x16_bf16 v[68:83], v[124:127], v[6:9], 0
    s_waitcnt lgkmcnt(4)
    v_mfma_f32_32x32x8_bf16 v[52:67], v[140:141], v[10:11], v[52:67]
    v_mfma_f32_32x32x8_bf16 v[68:83], v[140:141], v[14:15], v[68:83]
    s_nop 10
    v_max3_f32 v180, v52, v53, v54
    v_max3_f32 v180, v180, v55, v56
    v_max3_f32 v180, v180, v57, v58
    v_max3_f32 v180, v180, v59, v60
    v_max3_f32 v180, v180, v61, v62
    v_max3_f32 v180, v180, v63, v64
    v_max3_f32 v180, v180, v65, v66
    v_max_f32 v180, v180, v67
    v_mov_b32 v181, v180
    s_nop 1
    v_permlane32_swap_b32 v180, v181
    v_max_f32 v180, v180, v181
    v_sub_f32 v20, 0, v180
    v_sub_f32 v21, 0, v180
    v_sub_f32 v22, 0, v180
    v_sub_f32 v23, 0, v180
    v_sub_f32 v24, 0, v180
    v_sub_f32 v25, 0, v180
    v_sub_f32 v26, 0, v180
    v_sub_f32 v27, 0, v180
    v_sub_f32 v28, 0, v180
    v_sub_f32 v29, 0, v180
    v_sub_f32 v30, 0, v180
    v_sub_f32 v31, 0, v180
    v_sub_f32 v32, 0, v180
    v_sub_f32 v33, 0, v180
    v_sub_f32 v34, 0, v180
    v_sub_f32 v35, 0, v180
    v_max3_f32 v182, v68, v69, v70
    v_max3_f32 v182, v182, v71, v72
    v_max3_f32 v182, v182, v73, v74
    v_max3_f32 v182, v182, v75, v76
    v_max3_f32 v182, v182, v77, v78
    v_max3_f32 v182, v182, v79, v80
    v_max3_f32 v182, v182, v81, v82
    v_max_f32 v182, v182, v83
    v_mov_b32 v183, v182
    s_nop 1
    v_permlane32_swap_b32 v182, v183
    v_max_f32 v182, v182, v183
    v_sub_f32 v36, 0, v182
    v_sub_f32 v37, 0, v182
    v_sub_f32 v38, 0, v182
    v_sub_f32 v39, 0, v182
    v_sub_f32 v40, 0, v182
    v_sub_f32 v41, 0, v182
    v_sub_f32 v42, 0, v182
    v_sub_f32 v43, 0, v182
    v_sub_f32 v44, 0, v182
    v_sub_f32 v45, 0, v182
    v_sub_f32 v46, 0, v182
    v_sub_f32 v47, 0, v182
    v_sub_f32 v48, 0, v182
    v_sub_f32 v49, 0, v182
    v_sub_f32 v50, 0, v182
    v_sub_f32 v51, 0, v182
    v_sub_f32 v52, v52, v180
    v_sub_f32 v53, v53, v180
    v_sub_f32 v54, v54, v180
    v_sub_f32 v55, v55, v180
    v_sub_f32 v56, v56, v180
    v_sub_f32 v57, v57, v180
    v_sub_f32 v58, v58, v180
    v_sub_f32 v59, v59, v180
    v_sub_f32 v60, v60, v180
    v_sub_f32 v61, v61, v180
    v_sub_f32 v62, v62, v180
    v_sub_f32 v63, v63, v180
    v_sub_f32 v64, v64, v180
    v_sub_f32 v65, v65, v180
    v_sub_f32 v66, v66, v180
    v_sub_f32 v67, v67, v180
    s_mov_b32 s43, 0
    s_mov_b32 s44, 2082
P2_ALOOP:
    s_bitcmp0_b32 s44, s43
    s_cbranch_scc1 P2_ANB
    s_waitcnt vmcnt(0)
    s_barrier
P2_ANB:
    v_mfma_f32_32x32x16_bf16 v[68:83], v[124:127], v[6:9], v[36:51]
    ds_read_b64 v[132:133], v176 offset:512
    ds_read_b64 v[134:135], v176 offset:16896
    v_exp_f32 v52, v52
    v_exp_f32 v53, v53
    v_exp_f32 v54, v54
    v_exp_f32 v55, v55
    v_mfma_f32_32x32x16_bf16 v[100:115], v[172:175], v[120:123], v[100:115]
    ds_read_b128 v[152:155], v178 offset:1152
    v_exp_f32 v56, v56
    v_exp_f32 v57, v57
    v_exp_f32 v58, v58
    v_exp_f32 v59, v59
    v_mfma_f32_32x32x8_bf16 v[68:83], v[140:141], v[14:15], v[68:83]
    v_cvt_pk_bf16_f32 v116, v52, v53
    v_cvt_pk_bf16_f32 v117, v54, v55
    v_cvt_pk_bf16_f32 v118, v56, v57
    v_cvt_pk_bf16_f32 v119, v58, v59
    v_exp_f32 v60, v60
    v_exp_f32 v61, v61
    v_exp_f32 v62, v62
    s_waitcnt lgkmcnt(4)
    v_mfma_f32_32x32x16_bf16 v[84:99], v[144:147], v[116:119], v[84:99]
    v_exp_f32 v63, v63
    v_exp_f32 v64, v64
    v_exp_f32 v65, v65
    v_exp_f32 v66, v66
    v_exp_f32 v67, v67
    v_cvt_pk_bf16_f32 v120, v60, v61
    v_cvt_pk_bf16_f32 v121, v62, v63
    v_cvt_pk_bf16_f32 v122, v64, v65
    v_cvt_pk_bf16_f32 v123, v66, v67
    s_waitcnt lgkmcnt(3)
    v_mfma_f32_32x32x16_bf16 v[52:67], v[128:131], v[2:5], v[20:35]
    ds_read_b128 v[156:159], v178 offset:1728
    v_exp_f32 v68, v68
    v_exp_f32 v69, v69
    v_exp_f32 v70, v70
    v_exp_f32 v71, v71
    s_waitcnt lgkmcnt(4)
    v_mfma_f32_32x32x16_bf16 v[84:99], v[148:151], v[120:123], v[84:99]
    ds_read_b64 v[142:143], v177 offset:512
    v_exp_f32 v72, v72
    v_exp_f32 v73, v73
    v_exp_f32 v74, v74
    v_exp_f32 v75, v75
    v_mfma_f32_32x32x8_bf16 v[52:67], v[140:141], v[12:13], v[52:67]
    v_cvt_pk_bf16_f32 v116, v68, v69
    v_cvt_pk_bf16_f32 v117, v70, v71
    v_cvt_pk_bf16_f32 v118, v72, v73
    v_cvt_pk_bf16_f32 v119, v74, v75
    v_exp_f32 v76, v76
    v_exp_f32 v77, v77
    v_exp_f32 v78, v78
    v_mfma_f32_32x32x16_bf16 v[100:115], v[144:147], v[116:119], v[100:115]
    v_exp_f32 v79, v79
    v_exp_f32 v80, v80
    v_exp_f32 v81, v81
    v_exp_f32 v82, v82
    v_exp_f32 v83, v83
    v_cvt_pk_bf16_f32 v120, v76, v77
    v_cvt_pk_bf16_f32 v121, v78, v79
    v_cvt_pk_bf16_f32 v122, v80, v81
    v_cvt_pk_bf16_f32 v123, v82, v83
    v_mfma_f32_32x32x16_bf16 v[68:83], v[128:131], v[6:9], v[36:51]
    ds_read_b64 v[136:137], v176 offset:768
    ds_read_b64 v[138:139], v176 offset:17152
    v_exp_f32 v52, v52
    v_exp_f32 v53, v53
    v_exp_f32 v54, v54
    v_exp_f32 v55, v55
    v_mfma_f32_32x32x16_bf16 v[100:115], v[148:151], v[120:123], v[100:115]
    ds_read_b128 v[160:163], v178 offset:2304
    v_exp_f32 v56, v56
    v_exp_f32 v57, v57
    v_exp_f32 v58, v58
    v_exp_f32 v59, v59
    v_mfma_f32_32x32x8_bf16 v[68:83], v[140:141], v[16:17], v[68:83]
    v_cvt_pk_bf16_f32 v116, v52, v53
    v_cvt_pk_bf16_f32 v117, v54, v55
    v_cvt_pk_bf16_f32 v118, v56, v57
    v_cvt_pk_bf16_f32 v119, v58, v59
    v_exp_f32 v60, v60
    v_exp_f32 v61, v61
    v_exp_f32 v62, v62
    s_waitcnt lgkmcnt(5)
    v_mfma_f32_32x32x16_bf16 v[84:99], v[152:155], v[116:119], v[84:99]
    v_exp_f32 v63, v63
    v_exp_f32 v64, v64
    v_exp_f32 v65, v65
    v_exp_f32 v66, v66
    v_exp_f32 v67, v67
    v_cvt_pk_bf16_f32 v120, v60, v61
    v_cvt_pk_bf16_f32 v121, v62, v63
    v_cvt_pk_bf16_f32 v122, v64, v65
    v_cvt_pk_bf16_f32 v123, v66, v67
    v_mfma_f32_32x32x16_bf16 v[52:67], v[132:135], v[2:5], v[20:35]
    ds_read_b128 v[164:167], v178 offset:2880
    v_exp_f32 v68, v68
    v_exp_f32 v69, v69
    v_exp_f32 v70, v70
    v_exp_f32 v71, v71
    s_waitcnt lgkmcnt(5)
    v_mfma_f32_32x32x16_bf16 v[84:99], v[156:159], v[120:123], v[84:99]
    v_exp_f32 v72, v72
    v_exp_f32 v73, v73
    v_exp_f32 v74, v74
    v_exp_f32 v75, v75
    s_waitcnt lgkmcnt(4)
    v_mfma_f32_32x32x8_bf16 v[52:67], v[142:143], v[10:11], v[52:67]
    v_cvt_pk_bf16_f32 v116, v68, v69
    v_cvt_pk_bf16_f32 v117, v70, v71
    v_cvt_pk_bf16_f32 v118, v72, v73
    v_cvt_pk_bf16_f32 v119, v74, v75
    v_exp_f32 v76, v76
    v_exp_f32 v77, v77
    v_exp_f32 v78, v78
    v_mfma_f32_32x32x16_bf16 v[100:115], v[152:155], v[116:119], v[100:115]
    v_exp_f32 v79, v79
    v_exp_f32 v80, v80
    v_exp_f32 v81, v81
    v_exp_f32 v82, v82
    v_exp_f32 v83, v83
    v_cvt_pk_bf16_f32 v120, v76, v77
    v_cvt_pk_bf16_f32 v121, v78, v79
    v_cvt_pk_bf16_f32 v122, v80, v81
    v_cvt_pk_bf16_f32 v123, v82, v83
    v_mfma_f32_32x32x16_bf16 v[68:83], v[132:135], v[6:9], v[36:51]
    ds_read_b64 v[124:125], v176 offset:1024
    ds_read_b64 v[126:127], v176 offset:17408
    v_exp_f32 v52, v52
    v_exp_f32 v53, v53
    v_exp_f32 v54, v54
    v_exp_f32 v55, v55
    v_mfma_f32_32x32x16_bf16 v[100:115], v[156:159], v[120:123], v[100:115]
    ds_read_b128 v[168:171], v178 offset:3456
    v_exp_f32 v56, v56
    v_exp_f32 v57, v57
    v_exp_f32 v58, v58
    v_exp_f32 v59, v59
    v_mfma_f32_32x32x8_bf16 v[68:83], v[142:143], v[14:15], v[68:83]
    v_cvt_pk_bf16_f32 v116, v52, v53
    v_cvt_pk_bf16_f32 v117, v54, v55
    v_cvt_pk_bf16_f32 v118, v56, v57
    v_cvt_pk_bf16_f32 v119, v58, v59
    v_exp_f32 v60, v60
    v_exp_f32 v61, v61
    v_exp_f32 v62, v62
    s_waitcnt lgkmcnt(4)
    v_mfma_f32_32x32x16_bf16 v[84:99], v[160:163], v[116:119], v[84:99]
    v_exp_f32 v63, v63
    v_exp_f32 v64, v64
    v_exp_f32 v65, v65
    v_exp_f32 v66, v66
    v_exp_f32 v67, v67
    v_cvt_pk_bf16_f32 v120, v60, v61
    v_cvt_pk_bf16_f32 v121, v62, v63
    v_cvt_pk_bf16_f32 v122, v64, v65
    v_cvt_pk_bf16_f32 v123, v66, v67
    v_mfma_f32_32x32x16_bf16 v[52:67], v[136:139], v[2:5], v[20:35]
    ds_read_b128 v[172:175], v178 offset:4032
    v_exp_f32 v68, v68
    v_exp_f32 v69, v69
    v_exp_f32 v70, v70
    v_exp_f32 v71, v71
    s_waitcnt lgkmcnt(4)
    v_mfma_f32_32x32x16_bf16 v[84:99], v[164:167], v[120:123], v[84:99]
    ds_read_b64 v[140:141], v177 offset:1024
    v_exp_f32 v72, v72
    v_exp_f32 v73, v73
    v_exp_f32 v74, v74
    v_exp_f32 v75, v75
    v_mfma_f32_32x32x8_bf16 v[52:67], v[142:143], v[12:13], v[52:67]
    v_cvt_pk_bf16_f32 v116, v68, v69
    v_cvt_pk_bf16_f32 v117, v70, v71
    v_cvt_pk_bf16_f32 v118, v72, v73
    v_cvt_pk_bf16_f32 v119, v74, v75
    v_exp_f32 v76, v76
    v_exp_f32 v77, v77
    v_exp_f32 v78, v78
    v_mfma_f32_32x32x16_bf16 v[100:115], v[160:163], v[116:119], v[100:115]
    v_exp_f32 v79, v79
    v_exp_f32 v80, v80
    v_exp_f32 v81, v81
    v_exp_f32 v82, v82
    v_exp_f32 v83, v83
    v_cvt_pk_bf16_f32 v120, v76, v77
    v_cvt_pk_bf16_f32 v121, v78, v79
    v_cvt_pk_bf16_f32 v122, v80, v81
    v_cvt_pk_bf16_f32 v123, v82, v83
    v_mfma_f32_32x32x16_bf16 v[68:83], v[136:139], v[6:9], v[36:51]
    ds_read_b64 v[128:129], v176 offset:1280
    ds_read_b64 v[130:131], v176 offset:17664
    v_exp_f32 v52, v52
    v_exp_f32 v53, v53
    v_exp_f32 v54, v54
    v_exp_f32 v55, v55
    v_mfma_f32_32x32x16_bf16 v[100:115], v[164:167], v[120:123], v[100:115]
    ds_read_b128 v[144:147], v178 offset:4608
    v_exp_f32 v56, v56
    v_exp_f32 v57, v57
    v_exp_f32 v58, v58
    v_exp_f32 v59, v59
    v_mfma_f32_32x32x8_bf16 v[68:83], v[142:143], v[16:17], v[68:83]
    v_cvt_pk_bf16_f32 v116, v52, v53
    v_cvt_pk_bf16_f32 v117, v54, v55
    v_cvt_pk_bf16_f32 v118, v56, v57
    v_cvt_pk_bf16_f32 v119, v58, v59
    v_exp_f32 v60, v60
    v_exp_f32 v61, v61
    v_exp_f32 v62, v62
    s_waitcnt lgkmcnt(5)
    v_mfma_f32_32x32x16_bf16 v[84:99], v[168:171], v[116:119], v[84:99]
    v_exp_f32 v63, v63
    v_exp_f32 v64, v64
    v_exp_f32 v65, v65
    v_exp_f32 v66, v66
    v_exp_f32 v67, v67
    v_cvt_pk_bf16_f32 v120, v60, v61
    v_cvt_pk_bf16_f32 v121, v62, v63
    v_cvt_pk_bf16_f32 v122, v64, v65
    v_cvt_pk_bf16_f32 v123, v66, v67
    v_mfma_f32_32x32x16_bf16 v[52:67], v[124:127], v[2:5], v[20:35]
    ds_read_b128 v[148:151], v178 offset:5184
    v_exp_f32 v68, v68
    v_exp_f32 v69, v69
    v_exp_f32 v70, v70
    v_exp_f32 v71, v71
    s_waitcnt lgkmcnt(5)
    v_mfma_f32_32x32x16_bf16 v[84:99], v[172:175], v[120:123], v[84:99]
    v_exp_f32 v72, v72
    v_exp_f32 v73, v73
    v_exp_f32 v74, v74
    v_exp_f32 v75, v75
    s_waitcnt lgkmcnt(4)
    v_mfma_f32_32x32x8_bf16 v[52:67], v[140:141], v[10:11], v[52:67]
    v_cvt_pk_bf16_f32 v116, v68, v69
    v_cvt_pk_bf16_f32 v117, v70, v71
    v_cvt_pk_bf16_f32 v118, v72, v73
    v_cvt_pk_bf16_f32 v119, v74, v75
    v_exp_f32 v76, v76
    v_exp_f32 v77, v77
    v_exp_f32 v78, v78
    v_mfma_f32_32x32x16_bf16 v[100:115], v[168:171], v[116:119], v[100:115]
    v_exp_f32 v79, v79
    v_exp_f32 v80, v80
    v_exp_f32 v81, v81
    v_exp_f32 v82, v82
    v_exp_f32 v83, v83
    v_cvt_pk_bf16_f32 v120, v76, v77
    v_cvt_pk_bf16_f32 v121, v78, v79
    v_cvt_pk_bf16_f32 v122, v80, v81
    v_cvt_pk_bf16_f32 v123, v82, v83
    v_add_u32 v176, 1024, v176
    v_add_u32 v177, 1024, v177
    v_add_u32 v178, v179, v178
    s_add_u32 s43, s43, 1
    s_cmp_lt_u32 s43, 16
    s_cbranch_scc1 P2_ALOOP
    v_mfma_f32_32x32x16_bf16 v[100:115], v[172:175], v[120:123], v[100:115]
    v_mov_b32 v181, 0x7f800000
    v_mov_b32 v182, 0x53800000
    v_lshlrev_b32 v183, 2, v0
    v_and_b32 v190, 15, v0
    v_lshlrev_b32 v190, 4, v190
    v_bfe_u32 v180, v0, 4, 1
    v_lshl_add_u32 v190, v180, 14, v190
    v_lshrrev_b32 v180, 5, v0
    v_lshl_add_u32 v190, v180, 8, v190
    v_add_f32_e64 v180, abs(v84), abs(v85)
    v_add_f32_e64 v180, v180, abs(v86)
    v_add_f32_e64 v180, v180, abs(v87)
    v_add_f32_e64 v180, v180, abs(v88)
    v_add_f32_e64 v180, v180, abs(v89)
    v_add_f32_e64 v180, v180, abs(v90)
    v_add_f32_e64 v180, v180, abs(v91)
    v_add_f32_e64 v180, v180, abs(v92)
    v_add_f32_e64 v180, v180, abs(v93)
    v_cmp_nlt_f32 vcc, v180, v181
    v_cmp_nlt_f32 s[46:47], v94, v182
    s_nop 1
    s_or_b64 vcc, vcc, s[46:47]
    s_nop 0
    s_cbranch_vccnz P2_SLOW0
P2_AFIN0:
    v_rcp_f32 v180, v94
    s_add_u32 s31, s42, 0
    s_mul_i32 s31, s31, 36864
    s_lshl_b32 s32, s34, 9
    s_add_u32 s32, s32, s31
    s_add_u32 s32, s32, 37748736
    v_mul_f32 v84, v84, v180
    v_mul_f32 v85, v85, v180
    v_mul_f32 v86, v86, v180
    v_mul_f32 v87, v87, v180
    v_mul_f32 v88, v88, v180
    v_mul_f32 v89, v89, v180
    v_mul_f32 v90, v90, v180
    v_mul_f32 v91, v91, v180
    v_mul_f32 v92, v92, v180
    v_mul_f32 v93, v93, v180
    v_cvt_pk_bf16_f32 v84, v84, v85
    v_cvt_pk_bf16_f32 v85, v86, v87
    v_cvt_pk_bf16_f32 v86, v88, v89
    v_cvt_pk_bf16_f32 v87, v90, v91
    v_cvt_pk_bf16_f32 v88, v92, v93
    buffer_store_dwordx4 v[84:87], v190, s[20:23], s32 offen sc1
    s_lshl_b32 s32, s34, 7
    s_add_u32 s31, s31, s32
    s_add_u32 s31, s31, 37781504
    s_mov_b32 exec_hi, 0
    buffer_store_dword v88, v183, s[20:23], s31 offen sc1
    s_mov_b64 exec, -1
    v_add_f32_e64 v180, abs(v100), abs(v101)
    v_add_f32_e64 v180, v180, abs(v102)
    v_add_f32_e64 v180, v180, abs(v103)
    v_add_f32_e64 v180, v180, abs(v104)
    v_add_f32_e64 v180, v180, abs(v105)
    v_add_f32_e64 v180, v180, abs(v106)
    v_add_f32_e64 v180, v180, abs(v107)
    v_add_f32_e64 v180, v180, abs(v108)
    v_add_f32_e64 v180, v180, abs(v109)
    v_cmp_nlt_f32 vcc, v180, v181
    v_cmp_nlt_f32 s[46:47], v110, v182
    s_nop 1
    s_or_b64 vcc, vcc, s[46:47]
    s_nop 0
    s_cbranch_vccnz P2_SLOW1
P2_AFIN1:
    v_rcp_f32 v180, v110
    s_add_u32 s31, s42, 1
    s_mul_i32 s31, s31, 36864
    s_lshl_b32 s32, s34, 9
    s_add_u32 s32, s32, s31
    s_add_u32 s32, s32, 37748736
    v_mul_f32 v100, v100, v180
    v_mul_f32 v101, v101, v180
    v_mul_f32 v102, v102, v180
    v_mul_f32 v103, v103, v180
    v_mul_f32 v104, v104, v180
    v_mul_f32 v105, v105, v180
    v_mul_f32 v106, v106, v180
    v_mul_f32 v107, v107, v180
    v_mul_f32 v108, v108, v180
    v_mul_f32 v109, v109, v180
    v_cvt_pk_bf16_f32 v100, v100, v101
    v_cvt_pk_bf16_f32 v101, v102, v103
    v_cvt_pk_bf16_f32 v102, v104, v105
    v_cvt_pk_bf16_f32 v103, v106, v107
    v_cvt_pk_bf16_f32 v104, v108, v109
    buffer_store_dwordx4 v[100:103], v190, s[20:23], s32 offen sc1
    s_lshl_b32 s32, s34, 7
    s_add_u32 s31, s31, s32
    s_add_u32 s31, s31, 37781504
    s_mov_b32 exec_hi, 0
    buffer_store_dword v104, v183, s[20:23], s31 offen sc1
    s_mov_b64 exec, -1
    s_and_b32 s31, s30, 7
    s_lshl_b32 s31, s31, 6
    s_add_u32 s31, s31, s34
    s_waitcnt vmcnt(0) lgkmcnt(0)
    v_mov_b32 v2, 161808
P2_SIG:
    v_mov_b32 v3, 1
    s_lshl_b32 s31, s31, 2
    s_add_u32 s31, s31, 54525952
    v_mov_b32 v5, 0
    s_mov_b64 exec, 1
    ds_add_rtn_u32 v4, v2, v3
    s_waitcnt lgkmcnt(0)
    v_readfirstlane_b32 s33, v4
    s_nop 1
    s_cmp_lg_u32 s33, 3
    s_cbranch_scc1 P2_NOSIG
    buffer_store_dword v3, v5, s[20:23], s31 offen sc1
P2_NOSIG:
    s_mov_b64 exec, -1
    s_setprio 0
    s_branch P2_TAIL
P2_SLOW0:
    s_waitcnt lgkmcnt(0)
    v_subrev_u32 v186, 16384, v176
    v_subrev_u32 v187, 16384, v177
    v_mul_u32_u24 v184, 16, v179
    v_sub_u32 v188, v178, v184
    v_subrev_u32 v188, 81920, v188
    v_cmp_ne_u32 s[46:47], 0, v179
    v_mov_b32 v189, 0xff800000
    v_and_b32 v184, 27, v0
    v_cmp_eq_u32 vcc, 18, v184
    v_mov_b32 v185, 0x3f803f80
    s_nop 0
    v_cndmask_b32 v184, 0, v185, vcc
    s_mov_b32 s48, s37
    s_mov_b32 s43, 0
    v_mov_b32 v84, 0
    v_mov_b32 v85, 0
    v_mov_b32 v86, 0
    v_mov_b32 v87, 0
    v_mov_b32 v88, 0
    v_mov_b32 v89, 0
    v_mov_b32 v90, 0
    v_mov_b32 v91, 0
    v_mov_b32 v92, 0
    v_mov_b32 v93, 0
    v_mov_b32 v94, 0
    v_mov_b32 v95, 0
    v_mov_b32 v96, 0
    v_mov_b32 v97, 0
    v_mov_b32 v98, 0
    v_mov_b32 v99, 0
    v_mov_b32 v144, v184
    v_mov_b32 v145, v184
    v_mov_b32 v146, v184
    v_mov_b32 v147, v184
    v_mov_b32 v148, v184
    v_mov_b32 v149, v184
    v_mov_b32 v150, v184
    v_mov_b32 v151, v184
    v_mov_b32 v152, v184
    v_mov_b32 v153, v184
    v_mov_b32 v154, v184
    v_mov_b32 v155, v184
    v_mov_b32 v156, v184
    v_mov_b32 v157, v184
    v_mov_b32 v158, v184
    v_mov_b32 v159, v184
P2_SLOOP0:
    ds_read_b64 v[140:141], v187
    s_mov_b64 exec, s[46:47]
    buffer_load_dwordx4 v[144:147], v188, s[20:23], s48 offen offset:0 sc1
    buffer_load_dwordx4 v[148:151], v188, s[20:23], s48 offen offset:576 sc1
    buffer_load_dwordx4 v[152:155], v188, s[20:23], s48 offen offset:1152 sc1
    buffer_load_dwordx4 v[156:159], v188, s[20:23], s48 offen offset:1728 sc1
    s_mov_b64 exec, -1
    ds_read_b64 v[124:125], v186 offset:0
    ds_read_b64 v[126:127], v186 offset:16384
    s_waitcnt lgkmcnt(0)
    v_mfma_f32_32x32x16_bf16 v[52:67], v[124:127], v[2:5], 0
    v_mfma_f32_32x32x8_bf16 v[52:67], v[140:141], v[10:11], v[52:67]
    s_nop 11
    v_max3_f32 v184, v52, v53, v54
    v_max3_f32 v184, v184, v55, v56
    v_max3_f32 v184, v184, v57, v58
    v_max3_f32 v184, v184, v59, v60
    v_max3_f32 v184, v184, v61, v62
    v_max3_f32 v184, v184, v63, v64
    v_max3_f32 v184, v184, v65, v66
    v_max_f32 v184, v184, v67
    v_mov_b32 v185, v184
    s_nop 1
    v_permlane32_swap_b32 v184, v185
    v_max3_f32 v184, v184, v185, v189
    v_sub_f32 v185, v189, v184
    v_exp_f32 v185, v185
    v_mov_b32 v189, v184
    v_sub_f32 v52, v52, v184
    v_sub_f32 v53, v53, v184
    v_sub_f32 v54, v54, v184
    v_sub_f32 v55, v55, v184
    v_sub_f32 v56, v56, v184
    v_sub_f32 v57, v57, v184
    v_sub_f32 v58, v58, v184
    v_sub_f32 v59, v59, v184
    v_sub_f32 v60, v60, v184
    v_sub_f32 v61, v61, v184
    v_sub_f32 v62, v62, v184
    v_sub_f32 v63, v63, v184
    v_sub_f32 v64, v64, v184
    v_sub_f32 v65, v65, v184
    v_sub_f32 v66, v66, v184
    v_sub_f32 v67, v67, v184
    v_exp_f32 v52, v52
    v_exp_f32 v53, v53
    v_exp_f32 v54, v54
    v_exp_f32 v55, v55
    v_exp_f32 v56, v56
    v_exp_f32 v57, v57
    v_exp_f32 v58, v58
    v_exp_f32 v59, v59
    v_exp_f32 v60, v60
    v_exp_f32 v61, v61
    v_exp_f32 v62, v62
    v_exp_f32 v63, v63
    v_exp_f32 v64, v64
    v_exp_f32 v65, v65
    v_exp_f32 v66, v66
    v_exp_f32 v67, v67
    v_mul_f32 v84, v84, v185
    v_mul_f32 v85, v85, v185
    v_mul_f32 v86, v86, v185
    v_mul_f32 v87, v87, v185
    v_mul_f32 v88, v88, v185
    v_mul_f32 v89, v89, v185
    v_mul_f32 v90, v90, v185
    v_mul_f32 v91, v91, v185
    v_mul_f32 v92, v92, v185
    v_mul_f32 v93, v93, v185
    v_mul_f32 v94, v94, v185
    v_mul_f32 v95, v95, v185
    v_mul_f32 v96, v96, v185
    v_mul_f32 v97, v97, v185
    v_mul_f32 v98, v98, v185
    v_mul_f32 v99, v99, v185
    v_cvt_pk_bf16_f32 v116, v52, v53
    v_cvt_pk_bf16_f32 v117, v54, v55
    v_cvt_pk_bf16_f32 v118, v56, v57
    v_cvt_pk_bf16_f32 v119, v58, v59
    v_cvt_pk_bf16_f32 v120, v60, v61
    v_cvt_pk_bf16_f32 v121, v62, v63
    v_cvt_pk_bf16_f32 v122, v64, v65
    v_cvt_pk_bf16_f32 v123, v66, v67
    s_waitcnt vmcnt(3)
    v_mfma_f32_32x32x16_bf16 v[84:99], v[144:147], v[116:119], v[84:99]
    s_waitcnt vmcnt(2)
    v_mfma_f32_32x32x16_bf16 v[84:99], v[148:151], v[120:123], v[84:99]
    ds_read_b64 v[128:129], v186 offset:256
    ds_read_b64 v[130:131], v186 offset:16640
    s_waitcnt lgkmcnt(0)
    v_mfma_f32_32x32x16_bf16 v[52:67], v[128:131], v[2:5], 0
    v_mfma_f32_32x32x8_bf16 v[52:67], v[140:141], v[12:13], v[52:67]
    s_nop 11
    v_max3_f32 v184, v52, v53, v54
    v_max3_f32 v184, v184, v55, v56
    v_max3_f32 v184, v184, v57, v58
    v_max3_f32 v184, v184, v59, v60
    v_max3_f32 v184, v184, v61, v62
    v_max3_f32 v184, v184, v63, v64
    v_max3_f32 v184, v184, v65, v66
    v_max_f32 v184, v184, v67
    v_mov_b32 v185, v184
    s_nop 1
    v_permlane32_swap_b32 v184, v185
    v_max3_f32 v184, v184, v185, v189
    v_sub_f32 v185, v189, v184
    v_exp_f32 v185, v185
    v_mov_b32 v189, v184
    v_sub_f32 v52, v52, v184
    v_sub_f32 v53, v53, v184
    v_sub_f32 v54, v54, v184
    v_sub_f32 v55, v55, v184
    v_sub_f32 v56, v56, v184
    v_sub_f32 v57, v57, v184
    v_sub_f32 v58, v58, v184
    v_sub_f32 v59, v59, v184
    v_sub_f32 v60, v60, v184
    v_sub_f32 v61, v61, v184
    v_sub_f32 v62, v62, v184
    v_sub_f32 v63, v63, v184
    v_sub_f32 v64, v64, v184
    v_sub_f32 v65, v65, v184
    v_sub_f32 v66, v66, v184
    v_sub_f32 v67, v67, v184
    v_exp_f32 v52, v52
    v_exp_f32 v53, v53
    v_exp_f32 v54, v54
    v_exp_f32 v55, v55
    v_exp_f32 v56, v56
    v_exp_f32 v57, v57
    v_exp_f32 v58, v58
    v_exp_f32 v59, v59
    v_exp_f32 v60, v60
    v_exp_f32 v61, v61
    v_exp_f32 v62, v62
    v_exp_f32 v63, v63
    v_exp_f32 v64, v64
    v_exp_f32 v65, v65
    v_exp_f32 v66, v66
    v_exp_f32 v67, v67
    v_mul_f32 v84, v84, v185
    v_mul_f32 v85, v85, v185
    v_mul_f32 v86, v86, v185
    v_mul_f32 v87, v87, v185
    v_mul_f32 v88, v88, v185
    v_mul_f32 v89, v89, v185
    v_mul_f32 v90, v90, v185
    v_mul_f32 v91, v91, v185
    v_mul_f32 v92, v92, v185
    v_mul_f32 v93, v93, v185
    v_mul_f32 v94, v94, v185
    v_mul_f32 v95, v95, v185
    v_mul_f32 v96, v96, v185
    v_mul_f32 v97, v97, v185
    v_mul_f32 v98, v98, v185
    v_mul_f32 v99, v99, v185
    v_cvt_pk_bf16_f32 v116, v52, v53
    v_cvt_pk_bf16_f32 v117, v54, v55
    v_cvt_pk_bf16_f32 v118, v56, v57
    v_cvt_pk_bf16_f32 v119, v58, v59
    v_cvt_pk_bf16_f32 v120, v60, v61
    v_cvt_pk_bf16_f32 v121, v62, v63
    v_cvt_pk_bf16_f32 v122, v64, v65
    v_cvt_pk_bf16_f32 v123, v66, v67
    s_waitcnt vmcnt(1)
    v_mfma_f32_32x32x16_bf16 v[84:99], v[152:155], v[116:119], v[84:99]
    s_waitcnt vmcnt(0)
    v_mfma_f32_32x32x16_bf16 v[84:99], v[156:159], v[120:123], v[84:99]
    v_add_u32 v186, 512, v186
    v_add_u32 v187, 512, v187
    s_add_u32 s48, s48, 2304
    s_add_u32 s43, s43, 1
    s_cmp_lt_u32 s43, 32
    s_cbranch_scc1 P2_SLOOP0
    s_nop 15
    s_branch P2_AFIN0
P2_SLOW1:
    s_waitcnt lgkmcnt(0)
    v_subrev_u32 v186, 16384, v176
    v_subrev_u32 v187, 16384, v177
    v_mul_u32_u24 v184, 16, v179
    v_sub_u32 v188, v178, v184
    v_subrev_u32 v188, 81920, v188
    v_cmp_ne_u32 s[46:47], 0, v179
    v_mov_b32 v189, 0xff800000
    v_and_b32 v184, 27, v0
    v_cmp_eq_u32 vcc, 18, v184
    v_mov_b32 v185, 0x3f803f80
    s_nop 0
    v_cndmask_b32 v184, 0, v185, vcc
    s_mov_b32 s48, s37
    s_mov_b32 s43, 0
    v_mov_b32 v100, 0
    v_mov_b32 v101, 0
    v_mov_b32 v102, 0
    v_mov_b32 v103, 0
    v_mov_b32 v104, 0
    v_mov_b32 v105, 0
    v_mov_b32 v106, 0
    v_mov_b32 v107, 0
    v_mov_b32 v108, 0
    v_mov_b32 v109, 0
    v_mov_b32 v110, 0
    v_mov_b32 v111, 0
    v_mov_b32 v112, 0
    v_mov_b32 v113, 0
    v_mov_b32 v114, 0
    v_mov_b32 v115, 0
    v_mov_b32 v144, v184
    v_mov_b32 v145, v184
    v_mov_b32 v146, v184
    v_mov_b32 v147, v184
    v_mov_b32 v148, v184
    v_mov_b32 v149, v184
    v_mov_b32 v150, v184
    v_mov_b32 v151, v184
    v_mov_b32 v152, v184
    v_mov_b32 v153, v184
    v_mov_b32 v154, v184
    v_mov_b32 v155, v184
    v_mov_b32 v156, v184
    v_mov_b32 v157, v184
    v_mov_b32 v158, v184
    v_mov_b32 v159, v184
P2_SLOOP1:
    ds_read_b64 v[140:141], v187
    s_mov_b64 exec, s[46:47]
    buffer_load_dwordx4 v[144:147], v188, s[20:23], s48 offen offset:0 sc1
    buffer_load_dwordx4 v[148:151], v188, s[20:23], s48 offen offset:576 sc1
    buffer_load_dwordx4 v[152:155], v188, s[20:23], s48 offen offset:1152 sc1
    buffer_load_dwordx4 v[156:159], v188, s[20:23], s48 offen offset:1728 sc1
    s_mov_b64 exec, -1
    ds_read_b64 v[124:125], v186 offset:0
    ds_read_b64 v[126:127], v186 offset:16384
    s_waitcnt lgkmcnt(0)
    v_mfma_f32_32x32x16_bf16 v[68:83], v[124:127], v[6:9], 0
    v_mfma_f32_32x32x8_bf16 v[68:83], v[140:141], v[14:15], v[68:83]
    s_nop 11
    v_max3_f32 v184, v68, v69, v70
    v_max3_f32 v184, v184, v71, v72
    v_max3_f32 v184, v184, v73, v74
    v_max3_f32 v184, v184, v75, v76
    v_max3_f32 v184, v184, v77, v78
    v_max3_f32 v184, v184, v79, v80
    v_max3_f32 v184, v184, v81, v82
    v_max_f32 v184, v184, v83
    v_mov_b32 v185, v184
    s_nop 1
    v_permlane32_swap_b32 v184, v185
    v_max3_f32 v184, v184, v185, v189
    v_sub_f32 v185, v189, v184
    v_exp_f32 v185, v185
    v_mov_b32 v189, v184
    v_sub_f32 v68, v68, v184
    v_sub_f32 v69, v69, v184
    v_sub_f32 v70, v70, v184
    v_sub_f32 v71, v71, v184
    v_sub_f32 v72, v72, v184
    v_sub_f32 v73, v73, v184
    v_sub_f32 v74, v74, v184
    v_sub_f32 v75, v75, v184
    v_sub_f32 v76, v76, v184
    v_sub_f32 v77, v77, v184
    v_sub_f32 v78, v78, v184
    v_sub_f32 v79, v79, v184
    v_sub_f32 v80, v80, v184
    v_sub_f32 v81, v81, v184
    v_sub_f32 v82, v82, v184
    v_sub_f32 v83, v83, v184
    v_exp_f32 v68, v68
    v_exp_f32 v69, v69
    v_exp_f32 v70, v70
    v_exp_f32 v71, v71
    v_exp_f32 v72, v72
    v_exp_f32 v73, v73
    v_exp_f32 v74, v74
    v_exp_f32 v75, v75
    v_exp_f32 v76, v76
    v_exp_f32 v77, v77
    v_exp_f32 v78, v78
    v_exp_f32 v79, v79
    v_exp_f32 v80, v80
    v_exp_f32 v81, v81
    v_exp_f32 v82, v82
    v_exp_f32 v83, v83
    v_mul_f32 v100, v100, v185
    v_mul_f32 v101, v101, v185
    v_mul_f32 v102, v102, v185
    v_mul_f32 v103, v103, v185
    v_mul_f32 v104, v104, v185
    v_mul_f32 v105, v105, v185
    v_mul_f32 v106, v106, v185
    v_mul_f32 v107, v107, v185
    v_mul_f32 v108, v108, v185
    v_mul_f32 v109, v109, v185
    v_mul_f32 v110, v110, v185
    v_mul_f32 v111, v111, v185
    v_mul_f32 v112, v112, v185
    v_mul_f32 v113, v113, v185
    v_mul_f32 v114, v114, v185
    v_mul_f32 v115, v115, v185
    v_cvt_pk_bf16_f32 v116, v68, v69
    v_cvt_pk_bf16_f32 v117, v70, v71
    v_cvt_pk_bf16_f32 v118, v72, v73
    v_cvt_pk_bf16_f32 v119, v74, v75
    v_cvt_pk_bf16_f32 v120, v76, v77
    v_cvt_pk_bf16_f32 v121, v78, v79
    v_cvt_pk_bf16_f32 v122, v80, v81
    v_cvt_pk_bf16_f32 v123, v82, v83
    s_waitcnt vmcnt(3)
    v_mfma_f32_32x32x16_bf16 v[100:115], v[144:147], v[116:119], v[100:115]
    s_waitcnt vmcnt(2)
    v_mfma_f32_32x32x16_bf16 v[100:115], v[148:151], v[120:123], v[100:115]
    ds_read_b64 v[128:129], v186 offset:256
    ds_read_b64 v[130:131], v186 offset:16640
    s_waitcnt lgkmcnt(0)
    v_mfma_f32_32x32x16_bf16 v[68:83], v[128:131], v[6:9], 0
    v_mfma_f32_32x32x8_bf16 v[68:83], v[140:141], v[16:17], v[68:83]
    s_nop 11
    v_max3_f32 v184, v68, v69, v70
    v_max3_f32 v184, v184, v71, v72
    v_max3_f32 v184, v184, v73, v74
    v_max3_f32 v184, v184, v75, v76
    v_max3_f32 v184, v184, v77, v78
    v_max3_f32 v184, v184, v79, v80
    v_max3_f32 v184, v184, v81, v82
    v_max_f32 v184, v184, v83
    v_mov_b32 v185, v184
    s_nop 1
    v_permlane32_swap_b32 v184, v185
    v_max3_f32 v184, v184, v185, v189
    v_sub_f32 v185, v189, v184
    v_exp_f32 v185, v185
    v_mov_b32 v189, v184
    v_sub_f32 v68, v68, v184
    v_sub_f32 v69, v69, v184
    v_sub_f32 v70, v70, v184
    v_sub_f32 v71, v71, v184
    v_sub_f32 v72, v72, v184
    v_sub_f32 v73, v73, v184
    v_sub_f32 v74, v74, v184
    v_sub_f32 v75, v75, v184
    v_sub_f32 v76, v76, v184
    v_sub_f32 v77, v77, v184
    v_sub_f32 v78, v78, v184
    v_sub_f32 v79, v79, v184
    v_sub_f32 v80, v80, v184
    v_sub_f32 v81, v81, v184
    v_sub_f32 v82, v82, v184
    v_sub_f32 v83, v83, v184
    v_exp_f32 v68, v68
    v_exp_f32 v69, v69
    v_exp_f32 v70, v70
    v_exp_f32 v71, v71
    v_exp_f32 v72, v72
    v_exp_f32 v73, v73
    v_exp_f32 v74, v74
    v_exp_f32 v75, v75
    v_exp_f32 v76, v76
    v_exp_f32 v77, v77
    v_exp_f32 v78, v78
    v_exp_f32 v79, v79
    v_exp_f32 v80, v80
    v_exp_f32 v81, v81
    v_exp_f32 v82, v82
    v_exp_f32 v83, v83
    v_mul_f32 v100, v100, v185
    v_mul_f32 v101, v101, v185
    v_mul_f32 v102, v102, v185
    v_mul_f32 v103, v103, v185
    v_mul_f32 v104, v104, v185
    v_mul_f32 v105, v105, v185
    v_mul_f32 v106, v106, v185
    v_mul_f32 v107, v107, v185
    v_mul_f32 v108, v108, v185
    v_mul_f32 v109, v109, v185
    v_mul_f32 v110, v110, v185
    v_mul_f32 v111, v111, v185
    v_mul_f32 v112, v112, v185
    v_mul_f32 v113, v113, v185
    v_mul_f32 v114, v114, v185
    v_mul_f32 v115, v115, v185
    v_cvt_pk_bf16_f32 v116, v68, v69
    v_cvt_pk_bf16_f32 v117, v70, v71
    v_cvt_pk_bf16_f32 v118, v72, v73
    v_cvt_pk_bf16_f32 v119, v74, v75
    v_cvt_pk_bf16_f32 v120, v76, v77
    v_cvt_pk_bf16_f32 v121, v78, v79
    v_cvt_pk_bf16_f32 v122, v80, v81
    v_cvt_pk_bf16_f32 v123, v82, v83
    s_waitcnt vmcnt(1)
    v_mfma_f32_32x32x16_bf16 v[100:115], v[152:155], v[116:119], v[100:115]
    s_waitcnt vmcnt(0)
    v_mfma_f32_32x32x16_bf16 v[100:115], v[156:159], v[120:123], v[100:115]
    v_add_u32 v186, 512, v186
    v_add_u32 v187, 512, v187
    s_add_u32 s48, s48, 2304
    s_add_u32 s43, s43, 1
    s_cmp_lt_u32 s43, 32
    s_cbranch_scc1 P2_SLOOP1
    s_nop 15
    s_branch P2_AFIN1
P2_GEMM:
    s_sub_u32 s42, s28, 4
    s_add_u32 s50, s42, 0
    s_mul_i32 s51, s50, 205
    s_lshr_b32 s51, s51, 10
    s_mul_i32 s52, s51, 5
    s_sub_u32 s50, s50, s52
    s_lshl_b32 s50, s50, 14
    s_lshl_b32 s51, s51, 10
    s_add_u32 s50, s50, s51
    s_mov_b32 m0, s50
    s_add_u32 s50, s50, s36
    buffer_load_dwordx4 v1, s[20:23], s50 offen sc1 lds
    s_add_u32 s50, s42, 0
    s_lshl_b32 s50, s50, 10
    s_add_u32 m0, s50, 81920
    s_add_u32 s50, s50, s37
    buffer_load_dwordx4 v1, s[20:23], s50 offen sc1 lds
    s_add_u32 s50, s42, 4
    s_mul_i32 s51, s50, 205
    s_lshr_b32 s51, s51, 10
    s_mul_i32 s52, s51, 5
    s_sub_u32 s50, s50, s52
    s_lshl_b32 s50, s50, 14
    s_lshl_b32 s51, s51, 10
    s_add_u32 s50, s50, s51
    s_mov_b32 m0, s50
    s_add_u32 s50, s50, s36
    buffer_load_dwordx4 v1, s[20:23], s50 offen sc1 lds
    s_add_u32 s50, s42, 4
    s_lshl_b32 s50, s50, 10
    s_add_u32 m0, s50, 81920
    s_add_u32 s50, s50, s37
    buffer_load_dwordx4 v1, s[20:23], s50 offen sc1 lds
    s_add_u32 s50, s42, 8
    s_mul_i32 s51, s50, 205
    s_lshr_b32 s51, s51, 10
    s_mul_i32 s52, s51, 5
    s_sub_u32 s50, s50, s52
    s_lshl_b32 s50, s50, 14
    s_lshl_b32 s51, s51, 10
    s_add_u32 s50, s50, s51
    s_mov_b32 m0, s50
    s_add_u32 s50, s50, s36
    buffer_load_dwordx4 v1, s[20:23], s50 offen sc1 lds
    s_add_u32 s50, s42, 12
    s_mul_i32 s51, s50, 205
    s_lshr_b32 s51, s51, 10
    s_mul_i32 s52, s51, 5
    s_sub_u32 s50, s50, s52
    s_lshl_b32 s50, s50, 14
    s_lshl_b32 s51, s51, 10
    s_add_u32 s50, s50, s51
    s_mov_b32 m0, s50
    s_add_u32 s50, s50, s36
    buffer_load_dwordx4 v1, s[20:23], s50 offen sc1 lds
    s_add_u32 s50, s42, 8
    s_lshl_b32 s50, s50, 10
    s_add_u32 m0, s50, 81920
    s_add_u32 s50, s50, s37
    buffer_load_dwordx4 v1, s[20:23], s50 offen sc1 lds
    s_add_u32 s50, s42, 16
    s_mul_i32 s51, s50, 205
    s_lshr_b32 s51, s51, 10
    s_mul_i32 s52, s51, 5
    s_sub_u32 s50, s50, s52
    s_lshl_b32 s50, s50, 14
    s_lshl_b32 s51, s51, 10
    s_add_u32 s50, s50, s51
    s_mov_b32 m0, s50
    s_add_u32 s50, s50, s36
    buffer_load_dwordx4 v1, s[20:23], s50 offen sc1 lds
    s_waitcnt vmcnt(0)
    s_barrier
    s_cmp_lg_u32 s28, 4
    s_cbranch_scc1 P2_NH
    v_mov_b32 v254, 1
    v_mov_b32 v255, 0
    s_mov_b64 exec, 1
    buffer_store_dword v254, v255, s[20:23], s60 offen sc1
    s_mov_b64 exec, -1
P2_NH:
    s_add_u32 s50, s42, 12
    s_lshl_b32 s50, s50, 10
    s_add_u32 m0, s50, 81920
    s_add_u32 s50, s50, s37
    buffer_load_dwordx4 v1, s[20:23], s50 offen sc1 lds
    s_add_u32 s50, s42, 20
    s_mul_i32 s51, s50, 205
    s_lshr_b32 s51, s51, 10
    s_mul_i32 s52, s51, 5
    s_sub_u32 s50, s50, s52
    s_lshl_b32 s50, s50, 14
    s_lshl_b32 s51, s51, 10
    s_add_u32 s50, s50, s51
    s_mov_b32 m0, s50
    s_add_u32 s50, s50, s36
    buffer_load_dwordx4 v1, s[20:23], s50 offen sc1 lds
    s_add_u32 s50, s42, 16
    s_lshl_b32 s50, s50, 10
    s_add_u32 m0, s50, 81920
    s_add_u32 s50, s50, s37
    buffer_load_dwordx4 v1, s[20:23], s50 offen sc1 lds
    s_add_u32 s50, s42, 24
    s_mul_i32 s51, s50, 205
    s_lshr_b32 s51, s51, 10
    s_mul_i32 s52, s51, 5
    s_sub_u32 s50, s50, s52
    s_lshl_b32 s50, s50, 14
    s_lshl_b32 s51, s51, 10
    s_add_u32 s50, s50, s51
    s_mov_b32 m0, s50
    s_add_u32 s50, s50, s36
    buffer_load_dwordx4 v1, s[20:23], s50 offen sc1 lds
    s_add_u32 s50, s42, 20
    s_lshl_b32 s50, s50, 10
    s_add_u32 m0, s50, 81920
    s_add_u32 s50, s50, s37
    buffer_load_dwordx4 v1, s[20:23], s50 offen sc1 lds
    s_add_u32 s50, s42, 28
    s_mul_i32 s51, s50, 205
    s_lshr_b32 s51, s51, 10
    s_mul_i32 s52, s51, 5
    s_sub_u32 s50, s50, s52
    s_lshl_b32 s50, s50, 14
    s_lshl_b32 s51, s51, 10
    s_add_u32 s50, s50, s51
    s_mov_b32 m0, s50
    s_add_u32 s50, s50, s36
    buffer_load_dwordx4 v1, s[20:23], s50 offen sc1 lds
    s_lshr_b32 s31, s41, 3
    s_lshl_b32 s44, s29, 2
    s_add_u32 s44, s44, s31
    s_lshl_b32 s44, s44, 1
    s_and_b32 s55, s41, 1
    s_bfe_u32 s31, s41, 0x20001
    s_mul_i32 s32, s31, 9
    s_and_b32 s31, s31, 1
    s_add_u32 s43, s32, s31
    s_xor_b32 s31, s31, 1
    s_lshl_b32 s31, s31, 3
    s_add_u32 s49, s32, s31
    s_mul_i32 s31, s42, 36
    s_mul_i32 s32, s55, 18
    s_add_u32 s31, s31, s32
    s_mul_i32 s45, s44, 288
    s_add_u32 s45, s45, s31
    s_lshl_b32 s45, s45, 10
    s_add_u32 s45, s45, 8388608
    s_mul_i32 s31, s31, 36
    s_add_u32 s46, s31, s43
    s_lshl_b32 s46, s46, 10
    s_add_u32 s46, s46, 29360128
    s_add_u32 s53, s46, 4096
    s_add_u32 s54, s31, s49
    s_lshl_b32 s54, s54, 10
    s_add_u32 s54, s54, 29360128
    v_add_u32 v2, 147456, v1
    v_add_u32 v3, 294912, v1
    v_add_u32 v4, 442368, v1
    s_cmp_eq_u32 s55, 0
    s_cselect_b32 s49, 18, 18
    s_mov_b32 s48, 8200
    s_mov_b32 s16, s20
    s_mov_b32 s17, s21
    s_add_u32 s50, s44, 2
    s_mul_i32 s50, s50, 294912
    s_add_u32 s18, s50, 8388608
    s_mov_b32 s19, 0x20000
    buffer_load_dwordx4 v[184:187], v1, s[20:23], s46 offen offset:0 sc1
    buffer_load_dwordx4 v[188:191], v1, s[20:23], s46 offen offset:1024 sc1
    buffer_load_dwordx4 v[192:195], v1, s[20:23], s46 offen offset:2048 sc1
    buffer_load_dwordx4 v[196:199], v1, s[20:23], s46 offen offset:3072 sc1
    s_add_u32 s46, s46, 36864
    buffer_load_dwordx4 v[200:203], v1, s[20:23], s53 offen offset:0 sc1
    buffer_load_dwordx4 v[204:207], v1, s[20:23], s53 offen offset:1024 sc1
    buffer_load_dwordx4 v[208:211], v1, s[20:23], s53 offen offset:2048 sc1
    buffer_load_dwordx4 v[212:215], v1, s[20:23], s53 offen offset:3072 sc1
    s_add_u32 s53, s53, 36864
    buffer_load_dwordx4 v[216:219], v1, s[20:23], s54 offen offset:0 sc1
    s_add_u32 s54, s54, 36864
    v_mov_b32 v8, 0
    v_mov_b32 v9, 0
    v_mov_b32 v10, 0
    v_mov_b32 v11, 0
    v_mov_b32 v12, 0
    v_mov_b32 v13, 0
    v_mov_b32 v14, 0
    v_mov_b32 v15, 0
    v_mov_b32 v16, 0
    v_mov_b32 v17, 0
    v_mov_b32 v18, 0
    v_mov_b32 v19, 0
    v_mov_b32 v20, 0
    v_mov_b32 v21, 0
    v_mov_b32 v22, 0
    v_mov_b32 v23, 0
    v_mov_b32 v24, 0
    v_mov_b32 v25, 0
    v_mov_b32 v26, 0
    v_mov_b32 v27, 0
    v_mov_b32 v28, 0
    v_mov_b32 v29, 0
    v_mov_b32 v30, 0
    v_mov_b32 v31, 0
    v_mov_b32 v32, 0
    v_mov_b32 v33, 0
    v_mov_b32 v34, 0
    v_mov_b32 v35, 0
    v_mov_b32 v36, 0
    v_mov_b32 v37, 0
    v_mov_b32 v38, 0
    v_mov_b32 v39, 0
    v_mov_b32 v40, 0
    v_mov_b32 v41, 0
    v_mov_b32 v42, 0
    v_mov_b32 v43, 0
    v_mov_b32 v44, 0
    v_mov_b32 v45, 0
    v_mov_b32 v46, 0
    v_mov_b32 v47, 0
    v_mov_b32 v48, 0
    v_mov_b32 v49, 0
    v_mov_b32 v50, 0
    v_mov_b32 v51, 0
    v_mov_b32 v52, 0
    v_mov_b32 v53, 0
    v_mov_b32 v54, 0
    v_mov_b32 v55, 0
    v_mov_b32 v56, 0
    v_mov_b32 v57, 0
    v_mov_b32 v58, 0
    v_mov_b32 v59, 0
    v_mov_b32 v60, 0
    v_mov_b32 v61, 0
    v_mov_b32 v62, 0
    v_mov_b32 v63, 0
    v_mov_b32 v64, 0
    v_mov_b32 v65, 0
    v_mov_b32 v66, 0
    v_mov_b32 v67, 0
    v_mov_b32 v68, 0
    v_mov_b32 v69, 0
    v_mov_b32 v70, 0
    v_mov_b32 v71, 0
    v_mov_b32 v72, 0
    v_mov_b32 v73, 0
    v_mov_b32 v74, 0
    v_mov_b32 v75, 0
    v_mov_b32 v76, 0
    v_mov_b32 v77, 0
    v_mov_b32 v78, 0
    v_mov_b32 v79, 0
    v_mov_b32 v80, 0
    v_mov_b32 v81, 0
    v_mov_b32 v82, 0
    v_mov_b32 v83, 0
    v_mov_b32 v84, 0
    v_mov_b32 v85, 0
    v_mov_b32 v86, 0
    v_mov_b32 v87, 0
    v_mov_b32 v88, 0
    v_mov_b32 v89, 0
    v_mov_b32 v90, 0
    v_mov_b32 v91, 0
    v_mov_b32 v92, 0
    v_mov_b32 v93, 0
    v_mov_b32 v94, 0
    v_mov_b32 v95, 0
    v_mov_b32 v96, 0
    v_mov_b32 v97, 0
    v_mov_b32 v98, 0
    v_mov_b32 v99, 0
    v_mov_b32 v100, 0
    v_mov_b32 v101, 0
    v_mov_b32 v102, 0
    v_mov_b32 v103, 0
    v_mov_b32 v104, 0
    v_mov_b32 v105, 0
    v_mov_b32 v106, 0
    v_mov_b32 v107, 0
    v_mov_b32 v108, 0
    v_mov_b32 v109, 0
    v_mov_b32 v110, 0
    v_mov_b32 v111, 0
    v_mov_b32 v112, 0
    v_mov_b32 v113, 0
    v_mov_b32 v114, 0
    v_mov_b32 v115, 0
    v_mov_b32 v116, 0
    v_mov_b32 v117, 0
    v_mov_b32 v118, 0
    v_mov_b32 v119, 0
    v_mov_b32 v120, 0
    v_mov_b32 v121, 0
    v_mov_b32 v122, 0
    v_mov_b32 v123, 0
    v_mov_b32 v124, 0
    v_mov_b32 v125, 0
    v_mov_b32 v126, 0
    v_mov_b32 v127, 0
    v_mov_b32 v128, 0
    v_mov_b32 v129, 0
    v_mov_b32 v130, 0
    v_mov_b32 v131, 0
    v_mov_b32 v132, 0
    v_mov_b32 v133, 0
    v_mov_b32 v134, 0
    v_mov_b32 v135, 0
    v_mov_b32 v136, 0
    v_mov_b32 v137, 0
    v_mov_b32 v138, 0
    v_mov_b32 v139, 0
    v_mov_b32 v140, 0
    v_mov_b32 v141, 0
    v_mov_b32 v142, 0
    v_mov_b32 v143, 0
    v_mov_b32 v144, 0
    v_mov_b32 v145, 0
    v_mov_b32 v146, 0
    v_mov_b32 v147, 0
    v_mov_b32 v148, 0
    v_mov_b32 v149, 0
    v_mov_b32 v150, 0
    v_mov_b32 v151, 0
    s_lshr_b32 s50, s44, 2
    s_lshl_b32 s50, s50, 7
    s_add_u32 s50, s50, 54528000
    v_and_b32 v152, 15, v0
    v_lshlrev_b32 v152, 2, v152
    s_mov_b32 s51, 0
    buffer_load_dword v153, v152, s[20:23], s50 offen sc1
    s_waitcnt vmcnt(10)
    s_barrier
P2_HP:
    s_add_u32 s51, s51, 1
    s_waitcnt vmcnt(0)
    v_cmp_ne_u32 vcc, 1, v153
    s_cmp_ge_u32 s51, 0x20000
    s_cbranch_scc1 P2_HOK
    s_nop 2
    s_cbranch_vccz P2_HOK
    buffer_load_dword v153, v152, s[20:23], s50 offen sc1
    s_branch P2_HP
P2_HOK:
    buffer_load_dwordx4 v[152:155], v1, s[16:19], s45 offen sc1
    buffer_load_dwordx4 v[156:159], v2, s[16:19], s45 offen sc1
    buffer_load_dwordx4 v[160:163], v3, s[16:19], s45 offen sc1
    buffer_load_dwordx4 v[164:167], v4, s[16:19], s45 offen sc1
    s_add_u32 s45, s45, 1024
    buffer_load_dwordx4 v[168:171], v1, s[16:19], s45 offen sc1
    buffer_load_dwordx4 v[172:175], v2, s[16:19], s45 offen sc1
    buffer_load_dwordx4 v[176:179], v3, s[16:19], s45 offen sc1
    buffer_load_dwordx4 v[180:183], v4, s[16:19], s45 offen sc1
    s_add_u32 s45, s45, 1024
    s_waitcnt vmcnt(7)
    v_mfma_f32_16x16x32_bf16 v[8:11], v[184:187], v[152:155], v[8:11]
    s_add_u32 s50, s42, 32
    s_mul_i32 s51, s50, 205
    s_lshr_b32 s51, s51, 10
    s_mul_i32 s52, s51, 5
    s_sub_u32 s50, s50, s52
    s_lshl_b32 s50, s50, 14
    s_lshl_b32 s51, s51, 10
    s_add_u32 s50, s50, s51
    s_mov_b32 m0, s50
    s_add_u32 s50, s50, s36
    buffer_load_dwordx4 v1, s[20:23], s50 offen sc1 lds
    s_waitcnt vmcnt(7)
    v_mfma_f32_16x16x32_bf16 v[44:47], v[184:187], v[156:159], v[44:47]
    s_waitcnt vmcnt(6)
    v_mfma_f32_16x16x32_bf16 v[80:83], v[184:187], v[160:163], v[80:83]
    s_add_u32 s50, s42, 24
    s_lshl_b32 s50, s50, 10
    s_add_u32 m0, s50, 81920
    s_add_u32 s50, s50, s37
    buffer_load_dwordx4 v1, s[20:23], s50 offen sc1 lds
    s_waitcnt vmcnt(6)
    v_mfma_f32_16x16x32_bf16 v[116:119], v[184:187], v[164:167], v[116:119]
    buffer_load_dwordx4 v[184:187], v1, s[20:23], s46 offen offset:0 sc1
    v_mfma_f32_16x16x32_bf16 v[12:15], v[188:191], v[152:155], v[12:15]
    s_add_u32 s50, s42, 36
    s_mul_i32 s51, s50, 205
    s_lshr_b32 s51, s51, 10
    s_mul_i32 s52, s51, 5
    s_sub_u32 s50, s50, s52
    s_lshl_b32 s50, s50, 14
    s_lshl_b32 s51, s51, 10
    s_add_u32 s50, s50, s51
    s_mov_b32 m0, s50
    s_add_u32 s50, s50, s36
    buffer_load_dwordx4 v1, s[20:23], s50 offen sc1 lds
    v_mfma_f32_16x16x32_bf16 v[48:51], v[188:191], v[156:159], v[48:51]
    v_mfma_f32_16x16x32_bf16 v[84:87], v[188:191], v[160:163], v[84:87]
    s_add_u32 s50, s42, 28
    s_lshl_b32 s50, s50, 10
    s_add_u32 m0, s50, 81920
    s_add_u32 s50, s50, s37
    buffer_load_dwordx4 v1, s[20:23], s50 offen sc1 lds
    v_mfma_f32_16x16x32_bf16 v[120:123], v[188:191], v[164:167], v[120:123]
    buffer_load_dwordx4 v[188:191], v1, s[20:23], s46 offen offset:1024 sc1
    v_mfma_f32_16x16x32_bf16 v[16:19], v[192:195], v[152:155], v[16:19]
    s_add_u32 s50, s42, 40
    s_mul_i32 s51, s50, 205
    s_lshr_b32 s51, s51, 10
    s_mul_i32 s52, s51, 5
    s_sub_u32 s50, s50, s52
    s_lshl_b32 s50, s50, 14
    s_lshl_b32 s51, s51, 10
    s_add_u32 s50, s50, s51
    s_mov_b32 m0, s50
    s_add_u32 s50, s50, s36
    buffer_load_dwordx4 v1, s[20:23], s50 offen sc1 lds
    v_mfma_f32_16x16x32_bf16 v[52:55], v[192:195], v[156:159], v[52:55]
    v_mfma_f32_16x16x32_bf16 v[88:91], v[192:195], v[160:163], v[88:91]
    s_add_u32 s50, s42, 32
    s_lshl_b32 s50, s50, 10
    s_add_u32 m0, s50, 81920
    s_add_u32 s50, s50, s37
    buffer_load_dwordx4 v1, s[20:23], s50 offen sc1 lds
    v_mfma_f32_16x16x32_bf16 v[124:127], v[192:195], v[164:167], v[124:127]
    buffer_load_dwordx4 v[192:195], v1, s[20:23], s46 offen offset:2048 sc1
    v_mfma_f32_16x16x32_bf16 v[20:23], v[196:199], v[152:155], v[20:23]
    s_add_u32 s50, s42, 44
    s_mul_i32 s51, s50, 205
    s_lshr_b32 s51, s51, 10
    s_mul_i32 s52, s51, 5
    s_sub_u32 s50, s50, s52
    s_lshl_b32 s50, s50, 14
    s_lshl_b32 s51, s51, 10
    s_add_u32 s50, s50, s51
    s_mov_b32 m0, s50
    s_add_u32 s50, s50, s36
    buffer_load_dwordx4 v1, s[20:23], s50 offen sc1 lds
    v_mfma_f32_16x16x32_bf16 v[56:59], v[196:199], v[156:159], v[56:59]
    v_mfma_f32_16x16x32_bf16 v[92:95], v[196:199], v[160:163], v[92:95]
    s_add_u32 s50, s42, 36
    s_lshl_b32 s50, s50, 10
    s_add_u32 m0, s50, 81920
    s_add_u32 s50, s50, s37
    buffer_load_dwordx4 v1, s[20:23], s50 offen sc1 lds
    v_mfma_f32_16x16x32_bf16 v[128:131], v[196:199], v[164:167], v[128:131]
    buffer_load_dwordx4 v[196:199], v1, s[20:23], s46 offen offset:3072 sc1
    s_add_u32 s46, s46, 36864
    v_mfma_f32_16x16x32_bf16 v[24:27], v[200:203], v[152:155], v[24:27]
    s_add_u32 s50, s42, 48
    s_mul_i32 s51, s50, 205
    s_lshr_b32 s51, s51, 10
    s_mul_i32 s52, s51, 5
    s_sub_u32 s50, s50, s52
    s_lshl_b32 s50, s50, 14
    s_lshl_b32 s51, s51, 10
    s_add_u32 s50, s50, s51
    s_mov_b32 m0, s50
    s_add_u32 s50, s50, s36
    buffer_load_dwordx4 v1, s[20:23], s50 offen sc1 lds
    v_mfma_f32_16x16x32_bf16 v[60:63], v[200:203], v[156:159], v[60:63]
    v_mfma_f32_16x16x32_bf16 v[96:99], v[200:203], v[160:163], v[96:99]
    s_add_u32 s50, s42, 40
    s_lshl_b32 s50, s50, 10
    s_add_u32 m0, s50, 81920
    s_add_u32 s50, s50, s37
    buffer_load_dwordx4 v1, s[20:23], s50 offen sc1 lds
    v_mfma_f32_16x16x32_bf16 v[132:135], v[200:203], v[164:167], v[132:135]
    buffer_load_dwordx4 v[200:203], v1, s[20:23], s53 offen offset:0 sc1
    v_mfma_f32_16x16x32_bf16 v[28:31], v[204:207], v[152:155], v[28:31]
    s_add_u32 s50, s42, 52
    s_mul_i32 s51, s50, 205
    s_lshr_b32 s51, s51, 10
    s_mul_i32 s52, s51, 5
    s_sub_u32 s50, s50, s52
    s_lshl_b32 s50, s50, 14
    s_lshl_b32 s51, s51, 10
    s_add_u32 s50, s50, s51
    s_mov_b32 m0, s50
    s_add_u32 s50, s50, s36
    buffer_load_dwordx4 v1, s[20:23], s50 offen sc1 lds
    v_mfma_f32_16x16x32_bf16 v[64:67], v[204:207], v[156:159], v[64:67]
    v_mfma_f32_16x16x32_bf16 v[100:103], v[204:207], v[160:163], v[100:103]
    s_add_u32 s50, s42, 44
    s_lshl_b32 s50, s50, 10
    s_add_u32 m0, s50, 81920
    s_add_u32 s50, s50, s37
    buffer_load_dwordx4 v1, s[20:23], s50 offen sc1 lds
    v_mfma_f32_16x16x32_bf16 v[136:139], v[204:207], v[164:167], v[136:139]
    buffer_load_dwordx4 v[204:207], v1, s[20:23], s53 offen offset:1024 sc1
    v_mfma_f32_16x16x32_bf16 v[32:35], v[208:211], v[152:155], v[32:35]
    s_add_u32 s50, s42, 56
    s_mul_i32 s51, s50, 205
    s_lshr_b32 s51, s51, 10
    s_mul_i32 s52, s51, 5
    s_sub_u32 s50, s50, s52
    s_lshl_b32 s50, s50, 14
    s_lshl_b32 s51, s51, 10
    s_add_u32 s50, s50, s51
    s_mov_b32 m0, s50
    s_add_u32 s50, s50, s36
    buffer_load_dwordx4 v1, s[20:23], s50 offen sc1 lds
    v_mfma_f32_16x16x32_bf16 v[68:71], v[208:211], v[156:159], v[68:71]
    v_mfma_f32_16x16x32_bf16 v[104:107], v[208:211], v[160:163], v[104:107]
    s_add_u32 s50, s42, 48
    s_lshl_b32 s50, s50, 10
    s_add_u32 m0, s50, 81920
    s_add_u32 s50, s50, s37
    buffer_load_dwordx4 v1, s[20:23], s50 offen sc1 lds
    v_mfma_f32_16x16x32_bf16 v[140:143], v[208:211], v[164:167], v[140:143]
    buffer_load_dwordx4 v[208:211], v1, s[20:23], s53 offen offset:2048 sc1
    v_mfma_f32_16x16x32_bf16 v[36:39], v[212:215], v[152:155], v[36:39]
    s_add_u32 s50, s42, 60
    s_mul_i32 s51, s50, 205
    s_lshr_b32 s51, s51, 10
    s_mul_i32 s52, s51, 5
    s_sub_u32 s50, s50, s52
    s_lshl_b32 s50, s50, 14
    s_lshl_b32 s51, s51, 10
    s_add_u32 s50, s50, s51
    s_mov_b32 m0, s50
    s_add_u32 s50, s50, s36
    buffer_load_dwordx4 v1, s[20:23], s50 offen sc1 lds
    v_mfma_f32_16x16x32_bf16 v[72:75], v[212:215], v[156:159], v[72:75]
    v_mfma_f32_16x16x32_bf16 v[108:111], v[212:215], v[160:163], v[108:111]
    s_add_u32 s50, s42, 52
    s_lshl_b32 s50, s50, 10
    s_add_u32 m0, s50, 81920
    s_add_u32 s50, s50, s37
    buffer_load_dwordx4 v1, s[20:23], s50 offen sc1 lds
    v_mfma_f32_16x16x32_bf16 v[144:147], v[212:215], v[164:167], v[144:147]
    buffer_load_dwordx4 v[212:215], v1, s[20:23], s53 offen offset:3072 sc1
    s_add_u32 s53, s53, 36864
    v_mfma_f32_16x16x32_bf16 v[40:43], v[216:219], v[152:155], v[40:43]
    s_add_u32 s50, s42, 64
    s_mul_i32 s51, s50, 205
    s_lshr_b32 s51, s51, 10
    s_mul_i32 s52, s51, 5
    s_sub_u32 s50, s50, s52
    s_lshl_b32 s50, s50, 14
    s_lshl_b32 s51, s51, 10
    s_add_u32 s50, s50, s51
    s_mov_b32 m0, s50
    s_add_u32 s50, s50, s36
    buffer_load_dwordx4 v1, s[20:23], s50 offen sc1 lds
    buffer_load_dwordx4 v[152:155], v1, s[16:19], s45 offen sc1
    v_mfma_f32_16x16x32_bf16 v[76:79], v[216:219], v[156:159], v[76:79]
    buffer_load_dwordx4 v[156:159], v2, s[16:19], s45 offen sc1
    v_mfma_f32_16x16x32_bf16 v[112:115], v[216:219], v[160:163], v[112:115]
    s_add_u32 s50, s42, 56
    s_lshl_b32 s50, s50, 10
    s_add_u32 m0, s50, 81920
    s_add_u32 s50, s50, s37
    buffer_load_dwordx4 v1, s[20:23], s50 offen sc1 lds
    buffer_load_dwordx4 v[160:163], v3, s[16:19], s45 offen sc1
    v_mfma_f32_16x16x32_bf16 v[148:151], v[216:219], v[164:167], v[148:151]
    buffer_load_dwordx4 v[164:167], v4, s[16:19], s45 offen sc1
    s_add_u32 s45, s45, 1024
    buffer_load_dwordx4 v[216:219], v1, s[20:23], s54 offen offset:0 sc1
    s_add_u32 s54, s54, 36864
    s_waitcnt vmcnt(28)
    v_mfma_f32_16x16x32_bf16 v[8:11], v[184:187], v[168:171], v[8:11]
    s_add_u32 s50, s42, 68
    s_mul_i32 s51, s50, 205
    s_lshr_b32 s51, s51, 10
    s_mul_i32 s52, s51, 5
    s_sub_u32 s50, s50, s52
    s_lshl_b32 s50, s50, 14
    s_lshl_b32 s51, s51, 10
    s_add_u32 s50, s50, s51
    s_mov_b32 m0, s50
    s_add_u32 s50, s50, s36
    buffer_load_dwordx4 v1, s[20:23], s50 offen sc1 lds
    v_mfma_f32_16x16x32_bf16 v[44:47], v[184:187], v[172:175], v[44:47]
    v_mfma_f32_16x16x32_bf16 v[80:83], v[184:187], v[176:179], v[80:83]
    s_add_u32 s50, s42, 60
    s_lshl_b32 s50, s50, 10
    s_add_u32 m0, s50, 81920
    s_add_u32 s50, s50, s37
    buffer_load_dwordx4 v1, s[20:23], s50 offen sc1 lds
    v_mfma_f32_16x16x32_bf16 v[116:119], v[184:187], v[180:183], v[116:119]
    buffer_load_dwordx4 v[184:187], v1, s[20:23], s46 offen offset:0 sc1
    s_waitcnt vmcnt(28)
    v_mfma_f32_16x16x32_bf16 v[12:15], v[188:191], v[168:171], v[12:15]
    s_add_u32 s50, s42, 72
    s_mul_i32 s51, s50, 205
    s_lshr_b32 s51, s51, 10
    s_mul_i32 s52, s51, 5
    s_sub_u32 s50, s50, s52
    s_lshl_b32 s50, s50, 14
    s_lshl_b32 s51, s51, 10
    s_add_u32 s50, s50, s51
    s_mov_b32 m0, s50
    s_add_u32 s50, s50, s36
    buffer_load_dwordx4 v1, s[20:23], s50 offen sc1 lds
    v_mfma_f32_16x16x32_bf16 v[48:51], v[188:191], v[172:175], v[48:51]
    v_mfma_f32_16x16x32_bf16 v[84:87], v[188:191], v[176:179], v[84:87]
    s_add_u32 s50, s42, 64
    s_lshl_b32 s50, s50, 10
    s_add_u32 m0, s50, 81920
    s_add_u32 s50, s50, s37
    buffer_load_dwordx4 v1, s[20:23], s50 offen sc1 lds
    v_mfma_f32_16x16x32_bf16 v[120:123], v[188:191], v[180:183], v[120:123]
    buffer_load_dwordx4 v[188:191], v1, s[20:23], s46 offen offset:1024 sc1
    s_waitcnt vmcnt(28)
    v_mfma_f32_16x16x32_bf16 v[16:19], v[192:195], v[168:171], v[16:19]
    s_add_u32 s50, s42, 76
    s_mul_i32 s51, s50, 205
    s_lshr_b32 s51, s51, 10
    s_mul_i32 s52, s51, 5
    s_sub_u32 s50, s50, s52
    s_lshl_b32 s50, s50, 14
    s_lshl_b32 s51, s51, 10
    s_add_u32 s50, s50, s51
    s_mov_b32 m0, s50
    s_add_u32 s50, s50, s36
    buffer_load_dwordx4 v1, s[20:23], s50 offen sc1 lds
    v_mfma_f32_16x16x32_bf16 v[52:55], v[192:195], v[172:175], v[52:55]
    v_mfma_f32_16x16x32_bf16 v[88:91], v[192:195], v[176:179], v[88:91]
    s_add_u32 s50, s42, 68
    s_lshl_b32 s50, s50, 10
    s_add_u32 m0, s50, 81920
    s_add_u32 s50, s50, s37
    buffer_load_dwordx4 v1, s[20:23], s50 offen sc1 lds
    v_mfma_f32_16x16x32_bf16 v[124:127], v[192:195], v[180:183], v[124:127]
    buffer_load_dwordx4 v[192:195], v1, s[20:23], s46 offen offset:2048 sc1
    s_waitcnt vmcnt(28)
    v_mfma_f32_16x16x32_bf16 v[20:23], v[196:199], v[168:171], v[20:23]
    v_mfma_f32_16x16x32_bf16 v[56:59], v[196:199], v[172:175], v[56:59]
    v_mfma_f32_16x16x32_bf16 v[92:95], v[196:199], v[176:179], v[92:95]
    v_mfma_f32_16x16x32_bf16 v[128:131], v[196:199], v[180:183], v[128:131]
    buffer_load_dwordx4 v[196:199], v1, s[20:23], s46 offen offset:3072 sc1
    s_add_u32 s46, s46, 36864
    s_waitcnt vmcnt(26)
    v_mfma_f32_16x16x32_bf16 v[24:27], v[200:203], v[168:171], v[24:27]
    v_mfma_f32_16x16x32_bf16 v[60:63], v[200:203], v[172:175], v[60:63]
    v_mfma_f32_16x16x32_bf16 v[96:99], v[200:203], v[176:179], v[96:99]
    v_mfma_f32_16x16x32_bf16 v[132:135], v[200:203], v[180:183], v[132:135]
    buffer_load_dwordx4 v[200:203], v1, s[20:23], s53 offen offset:0 sc1
    s_waitcnt vmcnt(24)
    v_mfma_f32_16x16x32_bf16 v[28:31], v[204:207], v[168:171], v[28:31]
    v_mfma_f32_16x16x32_bf16 v[64:67], v[204:207], v[172:175], v[64:67]
    v_mfma_f32_16x16x32_bf16 v[100:103], v[204:207], v[176:179], v[100:103]
    v_mfma_f32_16x16x32_bf16 v[136:139], v[204:207], v[180:183], v[136:139]
    buffer_load_dwordx4 v[204:207], v1, s[20:23], s53 offen offset:1024 sc1
    s_waitcnt vmcnt(22)
    v_mfma_f32_16x16x32_bf16 v[32:35], v[208:211], v[168:171], v[32:35]
    v_mfma_f32_16x16x32_bf16 v[68:71], v[208:211], v[172:175], v[68:71]
    v_mfma_f32_16x16x32_bf16 v[104:107], v[208:211], v[176:179], v[104:107]
    v_mfma_f32_16x16x32_bf16 v[140:143], v[208:211], v[180:183], v[140:143]
    buffer_load_dwordx4 v[208:211], v1, s[20:23], s53 offen offset:2048 sc1
    s_waitcnt vmcnt(20)
    v_mfma_f32_16x16x32_bf16 v[36:39], v[212:215], v[168:171], v[36:39]
    v_mfma_f32_16x16x32_bf16 v[72:75], v[212:215], v[172:175], v[72:75]
    v_mfma_f32_16x16x32_bf16 v[108:111], v[212:215], v[176:179], v[108:111]
    v_mfma_f32_16x16x32_bf16 v[144:147], v[212:215], v[180:183], v[144:147]
    buffer_load_dwordx4 v[212:215], v1, s[20:23], s53 offen offset:3072 sc1
    s_add_u32 s53, s53, 36864
    s_waitcnt vmcnt(14)
    v_mfma_f32_16x16x32_bf16 v[40:43], v[216:219], v[168:171], v[40:43]
    buffer_load_dwordx4 v[168:171], v1, s[16:19], s45 offen sc1
    v_mfma_f32_16x16x32_bf16 v[76:79], v[216:219], v[172:175], v[76:79]
    buffer_load_dwordx4 v[172:175], v2, s[16:19], s45 offen sc1
    v_mfma_f32_16x16x32_bf16 v[112:115], v[216:219], v[176:179], v[112:115]
    buffer_load_dwordx4 v[176:179], v3, s[16:19], s45 offen sc1
    v_mfma_f32_16x16x32_bf16 v[148:151], v[216:219], v[180:183], v[148:151]
    buffer_load_dwordx4 v[180:183], v4, s[16:19], s45 offen sc1
    s_add_u32 s45, s45, 1024
    buffer_load_dwordx4 v[216:219], v1, s[20:23], s54 offen offset:0 sc1
    s_add_u32 s54, s54, 36864
    s_mov_b32 s47, 2
P2_GLOOP:
    s_bitcmp0_b32 s48, s47
    s_cbranch_scc1 P2_GNB0
    s_barrier
    s_cmp_lt_u32 s47, 13
    s_cbranch_scc1 P2_GNB0
    s_setprio 1
P2_GNB0:
    s_add_u32 s47, s47, 1
    s_waitcnt vmcnt(12)
    v_mfma_f32_16x16x32_bf16 v[8:11], v[184:187], v[152:155], v[8:11]
    v_mfma_f32_16x16x32_bf16 v[44:47], v[184:187], v[156:159], v[44:47]
    v_mfma_f32_16x16x32_bf16 v[80:83], v[184:187], v[160:163], v[80:83]
    v_mfma_f32_16x16x32_bf16 v[116:119], v[184:187], v[164:167], v[116:119]
    buffer_load_dwordx4 v[184:187], v1, s[20:23], s46 offen offset:0 sc1
    s_waitcnt vmcnt(12)
    v_mfma_f32_16x16x32_bf16 v[12:15], v[188:191], v[152:155], v[12:15]
    v_mfma_f32_16x16x32_bf16 v[48:51], v[188:191], v[156:159], v[48:51]
    v_mfma_f32_16x16x32_bf16 v[84:87], v[188:191], v[160:163], v[84:87]
    v_mfma_f32_16x16x32_bf16 v[120:123], v[188:191], v[164:167], v[120:123]
    buffer_load_dwordx4 v[188:191], v1, s[20:23], s46 offen offset:1024 sc1
    s_waitcnt vmcnt(12)
    v_mfma_f32_16x16x32_bf16 v[16:19], v[192:195], v[152:155], v[16:19]
    v_mfma_f32_16x16x32_bf16 v[52:55], v[192:195], v[156:159], v[52:55]
    v_mfma_f32_16x16x32_bf16 v[88:91], v[192:195], v[160:163], v[88:91]
    v_mfma_f32_16x16x32_bf16 v[124:127], v[192:195], v[164:167], v[124:127]
    buffer_load_dwordx4 v[192:195], v1, s[20:23], s46 offen offset:2048 sc1
    s_waitcnt vmcnt(12)
    v_mfma_f32_16x16x32_bf16 v[20:23], v[196:199], v[152:155], v[20:23]
    v_mfma_f32_16x16x32_bf16 v[56:59], v[196:199], v[156:159], v[56:59]
    v_mfma_f32_16x16x32_bf16 v[92:95], v[196:199], v[160:163], v[92:95]
    v_mfma_f32_16x16x32_bf16 v[128:131], v[196:199], v[164:167], v[128:131]
    buffer_load_dwordx4 v[196:199], v1, s[20:23], s46 offen offset:3072 sc1
    s_add_u32 s46, s46, 36864
    s_waitcnt vmcnt(12)
    v_mfma_f32_16x16x32_bf16 v[24:27], v[200:203], v[152:155], v[24:27]
    v_mfma_f32_16x16x32_bf16 v[60:63], v[200:203], v[156:159], v[60:63]
    v_mfma_f32_16x16x32_bf16 v[96:99], v[200:203], v[160:163], v[96:99]
    v_mfma_f32_16x16x32_bf16 v[132:135], v[200:203], v[164:167], v[132:135]
    buffer_load_dwordx4 v[200:203], v1, s[20:23], s53 offen offset:0 sc1
    s_waitcnt vmcnt(12)
    v_mfma_f32_16x16x32_bf16 v[28:31], v[204:207], v[152:155], v[28:31]
    v_mfma_f32_16x16x32_bf16 v[64:67], v[204:207], v[156:159], v[64:67]
    v_mfma_f32_16x16x32_bf16 v[100:103], v[204:207], v[160:163], v[100:103]
    v_mfma_f32_16x16x32_bf16 v[136:139], v[204:207], v[164:167], v[136:139]
    buffer_load_dwordx4 v[204:207], v1, s[20:23], s53 offen offset:1024 sc1
    s_waitcnt vmcnt(12)
    v_mfma_f32_16x16x32_bf16 v[32:35], v[208:211], v[152:155], v[32:35]
    v_mfma_f32_16x16x32_bf16 v[68:71], v[208:211], v[156:159], v[68:71]
    v_mfma_f32_16x16x32_bf16 v[104:107], v[208:211], v[160:163], v[104:107]
    v_mfma_f32_16x16x32_bf16 v[140:143], v[208:211], v[164:167], v[140:143]
    buffer_load_dwordx4 v[208:211], v1, s[20:23], s53 offen offset:2048 sc1
    s_waitcnt vmcnt(12)
    v_mfma_f32_16x16x32_bf16 v[36:39], v[212:215], v[152:155], v[36:39]
    v_mfma_f32_16x16x32_bf16 v[72:75], v[212:215], v[156:159], v[72:75]
    v_mfma_f32_16x16x32_bf16 v[108:111], v[212:215], v[160:163], v[108:111]
    v_mfma_f32_16x16x32_bf16 v[144:147], v[212:215], v[164:167], v[144:147]
    buffer_load_dwordx4 v[212:215], v1, s[20:23], s53 offen offset:3072 sc1
    s_add_u32 s53, s53, 36864
    s_waitcnt vmcnt(8)
    v_mfma_f32_16x16x32_bf16 v[40:43], v[216:219], v[152:155], v[40:43]
    buffer_load_dwordx4 v[152:155], v1, s[16:19], s45 offen sc1
    v_mfma_f32_16x16x32_bf16 v[76:79], v[216:219], v[156:159], v[76:79]
    buffer_load_dwordx4 v[156:159], v2, s[16:19], s45 offen sc1
    v_mfma_f32_16x16x32_bf16 v[112:115], v[216:219], v[160:163], v[112:115]
    buffer_load_dwordx4 v[160:163], v3, s[16:19], s45 offen sc1
    v_mfma_f32_16x16x32_bf16 v[148:151], v[216:219], v[164:167], v[148:151]
    buffer_load_dwordx4 v[164:167], v4, s[16:19], s45 offen sc1
    s_add_u32 s45, s45, 1024
    buffer_load_dwordx4 v[216:219], v1, s[20:23], s54 offen offset:0 sc1
    s_add_u32 s54, s54, 36864
    s_bitcmp0_b32 s48, s47
    s_cbranch_scc1 P2_GNB1
    s_barrier
    s_cmp_lt_u32 s47, 13
    s_cbranch_scc1 P2_GNB1
    s_setprio 1
P2_GNB1:
    s_add_u32 s47, s47, 1
    s_waitcnt vmcnt(12)
    v_mfma_f32_16x16x32_bf16 v[8:11], v[184:187], v[168:171], v[8:11]
    v_mfma_f32_16x16x32_bf16 v[44:47], v[184:187], v[172:175], v[44:47]
    v_mfma_f32_16x16x32_bf16 v[80:83], v[184:187], v[176:179], v[80:83]
    v_mfma_f32_16x16x32_bf16 v[116:119], v[184:187], v[180:183], v[116:119]
    buffer_load_dwordx4 v[184:187], v1, s[20:23], s46 offen offset:0 sc1
    s_waitcnt vmcnt(12)
    v_mfma_f32_16x16x32_bf16 v[12:15], v[188:191], v[168:171], v[12:15]
    v_mfma_f32_16x16x32_bf16 v[48:51], v[188:191], v[172:175], v[48:51]
    v_mfma_f32_16x16x32_bf16 v[84:87], v[188:191], v[176:179], v[84:87]
    v_mfma_f32_16x16x32_bf16 v[120:123], v[188:191], v[180:183], v[120:123]
    buffer_load_dwordx4 v[188:191], v1, s[20:23], s46 offen offset:1024 sc1
    s_waitcnt vmcnt(12)
    v_mfma_f32_16x16x32_bf16 v[16:19], v[192:195], v[168:171], v[16:19]
    v_mfma_f32_16x16x32_bf16 v[52:55], v[192:195], v[172:175], v[52:55]
    v_mfma_f32_16x16x32_bf16 v[88:91], v[192:195], v[176:179], v[88:91]
    v_mfma_f32_16x16x32_bf16 v[124:127], v[192:195], v[180:183], v[124:127]
    buffer_load_dwordx4 v[192:195], v1, s[20:23], s46 offen offset:2048 sc1
    s_waitcnt vmcnt(12)
    v_mfma_f32_16x16x32_bf16 v[20:23], v[196:199], v[168:171], v[20:23]
    v_mfma_f32_16x16x32_bf16 v[56:59], v[196:199], v[172:175], v[56:59]
    v_mfma_f32_16x16x32_bf16 v[92:95], v[196:199], v[176:179], v[92:95]
    v_mfma_f32_16x16x32_bf16 v[128:131], v[196:199], v[180:183], v[128:131]
    buffer_load_dwordx4 v[196:199], v1, s[20:23], s46 offen offset:3072 sc1
    s_add_u32 s46, s46, 36864
    s_waitcnt vmcnt(12)
    v_mfma_f32_16x16x32_bf16 v[24:27], v[200:203], v[168:171], v[24:27]
    v_mfma_f32_16x16x32_bf16 v[60:63], v[200:203], v[172:175], v[60:63]
    v_mfma_f32_16x16x32_bf16 v[96:99], v[200:203], v[176:179], v[96:99]
    v_mfma_f32_16x16x32_bf16 v[132:135], v[200:203], v[180:183], v[132:135]
    buffer_load_dwordx4 v[200:203], v1, s[20:23], s53 offen offset:0 sc1
    s_waitcnt vmcnt(12)
    v_mfma_f32_16x16x32_bf16 v[28:31], v[204:207], v[168:171], v[28:31]
    v_mfma_f32_16x16x32_bf16 v[64:67], v[204:207], v[172:175], v[64:67]
    v_mfma_f32_16x16x32_bf16 v[100:103], v[204:207], v[176:179], v[100:103]
    v_mfma_f32_16x16x32_bf16 v[136:139], v[204:207], v[180:183], v[136:139]
    buffer_load_dwordx4 v[204:207], v1, s[20:23], s53 offen offset:1024 sc1
    s_waitcnt vmcnt(12)
    v_mfma_f32_16x16x32_bf16 v[32:35], v[208:211], v[168:171], v[32:35]
    v_mfma_f32_16x16x32_bf16 v[68:71], v[208:211], v[172:175], v[68:71]
    v_mfma_f32_16x16x32_bf16 v[104:107], v[208:211], v[176:179], v[104:107]
    v_mfma_f32_16x16x32_bf16 v[140:143], v[208:211], v[180:183], v[140:143]
    buffer_load_dwordx4 v[208:211], v1, s[20:23], s53 offen offset:2048 sc1
    s_waitcnt vmcnt(12)
    v_mfma_f32_16x16x32_bf16 v[36:39], v[212:215], v[168:171], v[36:39]
    v_mfma_f32_16x16x32_bf16 v[72:75], v[212:215], v[172:175], v[72:75]
    v_mfma_f32_16x16x32_bf16 v[108:111], v[212:215], v[176:179], v[108:111]
    v_mfma_f32_16x16x32_bf16 v[144:147], v[212:215], v[180:183], v[144:147]
    buffer_load_dwordx4 v[212:215], v1, s[20:23], s53 offen offset:3072 sc1
    s_add_u32 s53, s53, 36864
    s_waitcnt vmcnt(8)
    v_mfma_f32_16x16x32_bf16 v[40:43], v[216:219], v[168:171], v[40:43]
    buffer_load_dwordx4 v[168:171], v1, s[16:19], s45 offen sc1
    v_mfma_f32_16x16x32_bf16 v[76:79], v[216:219], v[172:175], v[76:79]
    buffer_load_dwordx4 v[172:175], v2, s[16:19], s45 offen sc1
    v_mfma_f32_16x16x32_bf16 v[112:115], v[216:219], v[176:179], v[112:115]
    buffer_load_dwordx4 v[176:179], v3, s[16:19], s45 offen sc1
    v_mfma_f32_16x16x32_bf16 v[148:151], v[216:219], v[180:183], v[148:151]
    buffer_load_dwordx4 v[180:183], v4, s[16:19], s45 offen sc1
    s_add_u32 s45, s45, 1024
    buffer_load_dwordx4 v[216:219], v1, s[20:23], s54 offen offset:0 sc1
    s_add_u32 s54, s54, 36864
    s_cmp_lt_u32 s47, s49
    s_cbranch_scc1 P2_GLOOP
P2_GFIN:
    s_nop 7
    s_setprio 3
    s_mul_i32 s31, s42, 9216
    s_add_u32 s32, s31, 81920
    v_add_u32 v2, s32, v1
    v_lshlrev_b32 v4, 3, v0
    v_add_u32 v3, s32, v4
    s_lshl_b32 s32, s29, 5
    s_add_u32 s32, s32, s41
    s_mul_i32 s32, s32, 36864
    s_add_u32 s32, s32, s31
    s_add_u32 s32, s32, 41943040
    s_add_u32 s33, s32, 4096
    s_add_u32 s50, s32, 4608
    s_add_u32 s51, s32, 8704
    v_cvt_pk_bf16_f32 v8, v8, v9
    v_cvt_pk_bf16_f32 v9, v10, v11
    v_cvt_pk_bf16_f32 v10, v12, v13
    v_cvt_pk_bf16_f32 v11, v14, v15
    v_cvt_pk_bf16_f32 v16, v16, v17
    v_cvt_pk_bf16_f32 v17, v18, v19
    v_cvt_pk_bf16_f32 v18, v20, v21
    v_cvt_pk_bf16_f32 v19, v22, v23
    v_cvt_pk_bf16_f32 v24, v24, v25
    v_cvt_pk_bf16_f32 v25, v26, v27
    v_cvt_pk_bf16_f32 v26, v28, v29
    v_cvt_pk_bf16_f32 v27, v30, v31
    v_cvt_pk_bf16_f32 v32, v32, v33
    v_cvt_pk_bf16_f32 v33, v34, v35
    v_cvt_pk_bf16_f32 v34, v36, v37
    v_cvt_pk_bf16_f32 v35, v38, v39
    v_cvt_pk_bf16_f32 v40, v40, v41
    v_cvt_pk_bf16_f32 v41, v42, v43
    v_cvt_pk_bf16_f32 v44, v44, v45
    v_cvt_pk_bf16_f32 v45, v46, v47
    v_cvt_pk_bf16_f32 v46, v48, v49
    v_cvt_pk_bf16_f32 v47, v50, v51
    v_cvt_pk_bf16_f32 v52, v52, v53
    v_cvt_pk_bf16_f32 v53, v54, v55
    v_cvt_pk_bf16_f32 v54, v56, v57
    v_cvt_pk_bf16_f32 v55, v58, v59
    v_cvt_pk_bf16_f32 v60, v60, v61
    v_cvt_pk_bf16_f32 v61, v62, v63
    v_cvt_pk_bf16_f32 v62, v64, v65
    v_cvt_pk_bf16_f32 v63, v66, v67
    v_cvt_pk_bf16_f32 v68, v68, v69
    v_cvt_pk_bf16_f32 v69, v70, v71
    v_cvt_pk_bf16_f32 v70, v72, v73
    v_cvt_pk_bf16_f32 v71, v74, v75
    v_cvt_pk_bf16_f32 v76, v76, v77
    v_cvt_pk_bf16_f32 v77, v78, v79
    v_cvt_pk_bf16_f32 v80, v80, v81
    v_cvt_pk_bf16_f32 v81, v82, v83
    v_cvt_pk_bf16_f32 v82, v84, v85
    v_cvt_pk_bf16_f32 v83, v86, v87
    v_cvt_pk_bf16_f32 v88, v88, v89
    v_cvt_pk_bf16_f32 v89, v90, v91
    v_cvt_pk_bf16_f32 v90, v92, v93
    v_cvt_pk_bf16_f32 v91, v94, v95
    v_cvt_pk_bf16_f32 v96, v96, v97
    v_cvt_pk_bf16_f32 v97, v98, v99
    v_cvt_pk_bf16_f32 v98, v100, v101
    v_cvt_pk_bf16_f32 v99, v102, v103
    v_cvt_pk_bf16_f32 v104, v104, v105
    v_cvt_pk_bf16_f32 v105, v106, v107
    v_cvt_pk_bf16_f32 v106, v108, v109
    v_cvt_pk_bf16_f32 v107, v110, v111
    v_cvt_pk_bf16_f32 v112, v112, v113
    v_cvt_pk_bf16_f32 v113, v114, v115
    v_cvt_pk_bf16_f32 v116, v116, v117
    v_cvt_pk_bf16_f32 v117, v118, v119
    v_cvt_pk_bf16_f32 v118, v120, v121
    v_cvt_pk_bf16_f32 v119, v122, v123
    v_cvt_pk_bf16_f32 v124, v124, v125
    v_cvt_pk_bf16_f32 v125, v126, v127
    v_cvt_pk_bf16_f32 v126, v128, v129
    v_cvt_pk_bf16_f32 v127, v130, v131
    v_cvt_pk_bf16_f32 v132, v132, v133
    v_cvt_pk_bf16_f32 v133, v134, v135
    v_cvt_pk_bf16_f32 v134, v136, v137
    v_cvt_pk_bf16_f32 v135, v138, v139
    v_cvt_pk_bf16_f32 v140, v140, v141
    v_cvt_pk_bf16_f32 v141, v142, v143
    v_cvt_pk_bf16_f32 v142, v144, v145
    v_cvt_pk_bf16_f32 v143, v146, v147
    v_cvt_pk_bf16_f32 v148, v148, v149
    v_cvt_pk_bf16_f32 v149, v150, v151
    s_cmp_eq_u32 s55, 0
    s_cbranch_scc1 P2_GH0
    buffer_store_dwordx4 v[8:11], v1, s[20:23], s32 offen offset:0 sc1
    buffer_store_dwordx4 v[16:19], v1, s[20:23], s32 offen offset:1024 sc1
    buffer_store_dwordx4 v[24:27], v1, s[20:23], s32 offen offset:2048 sc1
    buffer_store_dwordx4 v[32:35], v1, s[20:23], s32 offen offset:3072 sc1
    buffer_store_dwordx2 v[40:41], v4, s[20:23], s33 offen sc1
    buffer_store_dwordx4 v[44:47], v1, s[20:23], s50 offen offset:0 sc1
    buffer_store_dwordx4 v[52:55], v1, s[20:23], s50 offen offset:1024 sc1
    buffer_store_dwordx4 v[60:63], v1, s[20:23], s50 offen offset:2048 sc1
    buffer_store_dwordx4 v[68:71], v1, s[20:23], s50 offen offset:3072 sc1
    buffer_store_dwordx2 v[76:77], v4, s[20:23], s51 offen sc1
    ds_write_b128 v2, v[80:83] offset:0
    ds_write_b128 v2, v[88:91] offset:1024
    ds_write_b128 v2, v[96:99] offset:2048
    ds_write_b128 v2, v[104:107] offset:3072
    ds_write_b64 v3, v[112:113] offset:4096
    ds_write_b128 v2, v[116:119] offset:4608
    ds_write_b128 v2, v[124:127] offset:5632
    ds_write_b128 v2, v[132:135] offset:6656
    ds_write_b128 v2, v[140:143] offset:7680
    ds_write_b64 v3, v[148:149] offset:8704
    s_branch P2_GH1
P2_GH0:
    buffer_store_dwordx4 v[80:83], v1, s[20:23], s32 offen offset:0 sc1
    buffer_store_dwordx4 v[88:91], v1, s[20:23], s32 offen offset:1024 sc1
    buffer_store_dwordx4 v[96:99], v1, s[20:23], s32 offen offset:2048 sc1
    buffer_store_dwordx4 v[104:107], v1, s[20:23], s32 offen offset:3072 sc1
    buffer_store_dwordx2 v[112:113], v4, s[20:23], s33 offen sc1
    buffer_store_dwordx4 v[116:119], v1, s[20:23], s50 offen offset:0 sc1
    buffer_store_dwordx4 v[124:127], v1, s[20:23], s50 offen offset:1024 sc1
    buffer_store_dwordx4 v[132:135], v1, s[20:23], s50 offen offset:2048 sc1
    buffer_store_dwordx4 v[140:143], v1, s[20:23], s50 offen offset:3072 sc1
    buffer_store_dwordx2 v[148:149], v4, s[20:23], s51 offen sc1
    ds_write_b128 v2, v[8:11] offset:0
    ds_write_b128 v2, v[16:19] offset:1024
    ds_write_b128 v2, v[24:27] offset:2048
    ds_write_b128 v2, v[32:35] offset:3072
    ds_write_b64 v3, v[40:41] offset:4096
    ds_write_b128 v2, v[44:47] offset:4608
    ds_write_b128 v2, v[52:55] offset:5632
    ds_write_b128 v2, v[60:63] offset:6656
    ds_write_b128 v2, v[68:71] offset:7680
    ds_write_b64 v3, v[76:77] offset:8704
P2_GH1:
    s_lshl_b32 s31, s29, 5
    s_add_u32 s31, s31, s41
    s_lshl_b32 s31, s31, 5
    s_add_u32 s31, s31, 1024
    s_waitcnt vmcnt(0) lgkmcnt(0)
    v_mov_b32 v2, 161840
    s_branch P2_SIG
P2_TAIL:
    s_mov_b32 s8, s56
    s_mov_b32 s9, s57
    s_mov_b32 s10, 2359296
    s_mov_b32 s11, 0x20000
    s_mov_b32 s12, s96
    s_mov_b32 s13, s97
    s_mov_b32 s14, 2359296
    s_mov_b32 s15, 0x20000
    s_lshr_b32 s31, s41, 3
    s_lshl_b32 s42, s29, 2
    s_add_u32 s42, s42, s31
    s_lshl_b32 s42, s42, 1
    s_and_b32 s45, s41, 1
    s_bfe_u32 s31, s41, 0x20001
    s_mul_i32 s32, s31, 9
    s_and_b32 s31, s31, 1
    s_add_u32 s43, s32, s31
    s_xor_b32 s31, s31, 1
    s_lshl_b32 s31, s31, 3
    s_add_u32 s44, s32, s31
    s_add_u32 s42, s42, s45
    v_and_b32 v3, 15, v0
    v_lshrrev_b32 v10, 4, v0
    v_lshlrev_b32 v8, 3, v0
    v_mov_b32 v5, 0xffff0000
    v_lshlrev_b32 v6, 9, v10
    v_lshl_add_u32 v6, v3, 2, v6
    v_add_u32 v6, 32768, v6
    v_mul_u32_u24 v2, 1152, v3
    v_lshl_add_u32 v2, v10, 4, v2
    s_mul_i32 s31, s42, 36864
    v_add_u32 v2, s31, v2
    s_mov_b32 s54, 18432
    s_lshl_b32 s46, s29, 5
    s_xor_b32 s31, s41, 1
    s_add_u32 s46, s46, s31
    s_mul_i32 s46, s46, 36864
    s_add_u32 s46, s46, 41943040
    s_lshl_b32 s48, s28, 10
    s_mul_i32 s49, s42, 36864
    s_add_u32 s49, s49, s48
    s_add_u32 s49, s49, 37748736
    s_cmp_ge_u32 s28, 4
    s_cbranch_scc1 P2_TP
    s_cmp_ge_u32 s28, 2
    s_cbranch_scc1 P2_TD
    s_lshl_b32 s33, s44, 10
    s_add_u32 s33, s33, 40894464
    buffer_load_dwordx4 v[12:15], v1, s[20:23], s33 offen sc1
    s_add_u32 s33, s33, 36864
    buffer_load_dwordx4 v[16:19], v1, s[20:23], s33 offen sc1
    s_add_u32 s33, s33, 36864
    buffer_load_dwordx4 v[20:23], v1, s[20:23], s33 offen sc1
    s_add_u32 s33, s33, 36864
    buffer_load_dwordx4 v[24:27], v1, s[20:23], s33 offen sc1
    s_add_u32 s33, s33, 36864
    buffer_load_dwordx4 v[28:31], v1, s[20:23], s33 offen sc1
    s_add_u32 s33, s33, 36864
    buffer_load_dwordx4 v[32:35], v1, s[20:23], s33 offen sc1
    s_add_u32 s33, s33, 36864
    buffer_load_dwordx4 v[36:39], v1, s[20:23], s33 offen sc1
    s_add_u32 s33, s33, 36864
    buffer_load_dwordx4 v[40:43], v1, s[20:23], s33 offen sc1
    s_add_u32 s33, s33, 36864
    buffer_load_dwordx4 v[44:47], v1, s[20:23], s33 offen sc1
    s_add_u32 s33, s33, 36864
    buffer_load_dwordx4 v[48:51], v1, s[20:23], s33 offen sc1
    s_add_u32 s33, s33, 36864
    buffer_load_dwordx4 v[52:55], v1, s[20:23], s33 offen sc1
    s_add_u32 s33, s33, 36864
    buffer_load_dwordx4 v[56:59], v1, s[20:23], s33 offen sc1
    s_add_u32 s33, s33, 36864
    buffer_load_dwordx4 v[60:63], v1, s[20:23], s33 offen sc1
    s_add_u32 s33, s33, 36864
    buffer_load_dwordx4 v[64:67], v1, s[20:23], s33 offen sc1
    s_add_u32 s33, s33, 36864
    buffer_load_dwordx4 v[68:71], v1, s[20:23], s33 offen sc1
    s_add_u32 s33, s33, 36864
    buffer_load_dwordx4 v[72:75], v1, s[20:23], s33 offen sc1
    s_add_u32 s33, s33, 36864
    buffer_load_dwordx4 v[76:79], v1, s[20:23], s33 offen sc1
    s_add_u32 s33, s33, 36864
    buffer_load_dwordx4 v[80:83], v1, s[20:23], s33 offen sc1
    s_add_u32 s33, s33, 36864
    s_lshr_b32 s31, s44, 1
    s_lshl_b32 s31, s31, 6
    s_and_b32 s32, s44, 1
    s_lshl_b32 s32, s32, 3
    s_add_u32 s31, s31, s32
    s_mul_i32 s32, s28, 18432
    s_add_u32 s31, s31, s32
    v_add_u32 v2, s31, v2
    buffer_load_dwordx2 v[204:205], v2, s[8:11], 0 offen
    s_lshl_b32 s31, s28, 14
    v_add_u32 v4, s31, v1
    s_lshl_b32 s31, s28, 6
    v_add_u32 v6, s31, v6
    s_mul_i32 s31, s28, 4608
    s_add_u32 s31, s31, 4096
    s_add_u32 s46, s46, s31
    s_add_u32 s31, s31, 81920
    v_add_u32 v7, s31, v8
    s_barrier
    buffer_load_dwordx2 v[92:93], v8, s[20:23], s46 offen sc1
    s_add_u32 s46, s46, 9216
    buffer_load_dwordx2 v[94:95], v8, s[20:23], s46 offen sc1
    s_add_u32 s46, s46, 9216
    buffer_load_dwordx2 v[96:97], v8, s[20:23], s46 offen sc1
    s_add_u32 s46, s46, 9216
    buffer_load_dwordx2 v[98:99], v8, s[20:23], s46 offen sc1
    s_add_u32 s46, s46, 9216
    ds_read_b64 v[172:173], v7 offset:0
    ds_read_b64 v[174:175], v7 offset:9216
    ds_read_b64 v[176:177], v7 offset:18432
    ds_read_b64 v[178:179], v7 offset:27648
    s_waitcnt lgkmcnt(3)
    v_lshlrev_b32 v212, 16, v172
    v_and_b32 v213, v5, v172
    v_lshlrev_b32 v214, 16, v173
    v_and_b32 v215, v5, v173
    s_waitcnt lgkmcnt(2)
    v_lshlrev_b32 v10, 16, v174
    v_and_b32 v11, v5, v174
    v_add_f32 v212, v212, v10
    v_add_f32 v213, v213, v11
    v_lshlrev_b32 v10, 16, v175
    v_and_b32 v11, v5, v175
    v_add_f32 v214, v214, v10
    v_add_f32 v215, v215, v11
    s_waitcnt lgkmcnt(1)
    v_lshlrev_b32 v10, 16, v176
    v_and_b32 v11, v5, v176
    v_add_f32 v212, v212, v10
    v_add_f32 v213, v213, v11
    v_lshlrev_b32 v10, 16, v177
    v_and_b32 v11, v5, v177
    v_add_f32 v214, v214, v10
    v_add_f32 v215, v215, v11
    s_waitcnt lgkmcnt(0)
    v_lshlrev_b32 v10, 16, v178
    v_and_b32 v11, v5, v178
    v_add_f32 v212, v212, v10
    v_add_f32 v213, v213, v11
    v_lshlrev_b32 v10, 16, v179
    v_and_b32 v11, v5, v179
    v_add_f32 v214, v214, v10
    v_add_f32 v215, v215, v11
    s_barrier
    s_add_u32 m0, s48, 0
    s_add_u32 s31, s49, 0
    buffer_load_dwordx4 v1, s[20:23], s31 offen sc1 lds
    s_add_u32 m0, s48, 16384
    s_add_u32 s31, s49, 16384
    buffer_load_dwordx4 v1, s[20:23], s31 offen sc1 lds
    s_add_u32 m0, s48, 8192
    s_add_u32 s31, s49, 8192
    buffer_load_dwordx4 v1, s[20:23], s31 offen sc1 lds
    s_add_u32 m0, s48, 24576
    s_add_u32 s31, s49, 24576
    buffer_load_dwordx4 v1, s[20:23], s31 offen sc1 lds
    s_add_u32 m0, s48, 32768
    s_add_u32 s31, s49, 32768
    buffer_load_dwordx4 v1, s[20:23], s31 offen sc1 lds
    s_waitcnt vmcnt(3)
    s_barrier
    ds_read_b128 v[172:175], v4 offset:0
    ds_read_b128 v[176:179], v4 offset:1024
    ds_read_b128 v[180:183], v4 offset:2048
    ds_read_b128 v[184:187], v4 offset:3072
    ds_read_b128 v[188:191], v4 offset:4096
    ds_read_b128 v[192:195], v4 offset:5120
    ds_read_b128 v[196:199], v4 offset:6144
    ds_read_b128 v[200:203], v4 offset:7168
    s_waitcnt lgkmcnt(7)
    v_mfma_f32_16x16x32_bf16 v[156:159], v[12:15], v[172:175], 0
    s_waitcnt lgkmcnt(6)
    v_mfma_f32_16x16x32_bf16 v[156:159], v[16:19], v[176:179], v[156:159]
    s_waitcnt lgkmcnt(5)
    v_mfma_f32_16x16x32_bf16 v[156:159], v[20:23], v[180:183], v[156:159]
    s_waitcnt lgkmcnt(4)
    v_mfma_f32_16x16x32_bf16 v[156:159], v[24:27], v[184:187], v[156:159]
    s_waitcnt lgkmcnt(3)
    v_mfma_f32_16x16x32_bf16 v[156:159], v[28:31], v[188:191], v[156:159]
    s_waitcnt lgkmcnt(2)
    v_mfma_f32_16x16x32_bf16 v[156:159], v[32:35], v[192:195], v[156:159]
    s_waitcnt lgkmcnt(1)
    v_mfma_f32_16x16x32_bf16 v[156:159], v[36:39], v[196:199], v[156:159]
    s_waitcnt lgkmcnt(0)
    v_mfma_f32_16x16x32_bf16 v[156:159], v[40:43], v[200:203], v[156:159]
    s_waitcnt vmcnt(0)
    s_barrier
    ds_read_b128 v[172:175], v4 offset:8192
    ds_read_b128 v[176:179], v4 offset:9216
    ds_read_b128 v[180:183], v4 offset:10240
    ds_read_b128 v[184:187], v4 offset:11264
    ds_read_b128 v[188:191], v4 offset:12288
    ds_read_b128 v[192:195], v4 offset:13312
    ds_read_b128 v[196:199], v4 offset:14336
    ds_read_b128 v[200:203], v4 offset:15360
    v_lshlrev_b32 v10, 16, v92
    v_and_b32 v11, v5, v92
    v_add_f32 v212, v212, v10
    v_add_f32 v213, v213, v11
    v_lshlrev_b32 v10, 16, v93
    v_and_b32 v11, v5, v93
    v_add_f32 v214, v214, v10
    v_add_f32 v215, v215, v11
    v_lshlrev_b32 v10, 16, v94
    v_and_b32 v11, v5, v94
    v_add_f32 v212, v212, v10
    v_add_f32 v213, v213, v11
    v_lshlrev_b32 v10, 16, v95
    v_and_b32 v11, v5, v95
    v_add_f32 v214, v214, v10
    v_add_f32 v215, v215, v11
    v_lshlrev_b32 v10, 16, v96
    v_and_b32 v11, v5, v96
    v_add_f32 v212, v212, v10
    v_add_f32 v213, v213, v11
    v_lshlrev_b32 v10, 16, v97
    v_and_b32 v11, v5, v97
    v_add_f32 v214, v214, v10
    v_add_f32 v215, v215, v11
    v_lshlrev_b32 v10, 16, v98
    v_and_b32 v11, v5, v98
    v_add_f32 v212, v212, v10
    v_add_f32 v213, v213, v11
    v_lshlrev_b32 v10, 16, v99
    v_and_b32 v11, v5, v99
    v_add_f32 v214, v214, v10
    v_add_f32 v215, v215, v11
    v_mul_f32 v228, 0xbfb8aa3b, v212
    v_mul_f32 v229, 0xbfb8aa3b, v213
    v_mul_f32 v230, 0xbfb8aa3b, v214
    v_mul_f32 v231, 0xbfb8aa3b, v215
    v_exp_f32 v228, v228
    v_exp_f32 v229, v229
    v_exp_f32 v230, v230
    v_exp_f32 v231, v231
    v_add_f32 v228, 1.0, v228
    v_add_f32 v229, 1.0, v229
    v_add_f32 v230, 1.0, v230
    v_add_f32 v231, 1.0, v231
    v_rcp_f32 v228, v228
    v_rcp_f32 v229, v229
    v_rcp_f32 v230, v230
    v_rcp_f32 v231, v231
    v_mul_f32 v228, v228, v212
    v_mul_f32 v229, v229, v213
    v_mul_f32 v230, v230, v214
    v_mul_f32 v231, v231, v215
    v_lshlrev_b32 v212, 16, v204
    v_and_b32 v213, v5, v204
    v_lshlrev_b32 v214, 16, v205
    v_and_b32 v215, v5, v205
    s_waitcnt lgkmcnt(7)
    v_mfma_f32_16x16x32_bf16 v[156:159], v[44:47], v[172:175], v[156:159]
    ds_read_b32 v172, v6 offset:0
    ds_read_b32 v173, v6 offset:128
    ds_read_b32 v174, v6 offset:256
    ds_read_b32 v175, v6 offset:384
    s_waitcnt lgkmcnt(10)
    v_mfma_f32_16x16x32_bf16 v[156:159], v[48:51], v[176:179], v[156:159]
    ds_read_b32 v176, v6 offset:2048
    ds_read_b32 v177, v6 offset:2176
    ds_read_b32 v178, v6 offset:2304
    ds_read_b32 v179, v6 offset:2432
    s_waitcnt lgkmcnt(13)
    v_mfma_f32_16x16x32_bf16 v[156:159], v[52:55], v[180:183], v[156:159]
    s_waitcnt lgkmcnt(12)
    v_mfma_f32_16x16x32_bf16 v[156:159], v[56:59], v[184:187], v[156:159]
    s_waitcnt lgkmcnt(11)
    v_mfma_f32_16x16x32_bf16 v[156:159], v[60:63], v[188:191], v[156:159]
    s_waitcnt lgkmcnt(10)
    v_mfma_f32_16x16x32_bf16 v[156:159], v[64:67], v[192:195], v[156:159]
    s_waitcnt lgkmcnt(9)
    v_mfma_f32_16x16x32_bf16 v[156:159], v[68:71], v[196:199], v[156:159]
    s_waitcnt lgkmcnt(8)
    v_mfma_f32_16x16x32_bf16 v[156:159], v[72:75], v[200:203], v[156:159]
    s_waitcnt lgkmcnt(4)
    v_mfma_f32_16x16x32_bf16 v[156:159], v[76:79], v[172:175], v[156:159]
    s_waitcnt lgkmcnt(0)
    v_mfma_f32_16x16x32_bf16 v[156:159], v[80:83], v[176:179], v[156:159]
    s_nop 7
    v_fmac_f32 v212, v156, v228
    v_fmac_f32 v213, v157, v229
    v_fmac_f32 v214, v158, v230
    v_fmac_f32 v215, v159, v231
    v_cvt_pk_bf16_f32 v204, v212, v213
    v_cvt_pk_bf16_f32 v205, v214, v215
    buffer_store_dwordx2 v[204:205], v2, s[12:15], 0 offen
    s_endpgm
P2_TD:
    s_barrier
    s_cmp_lg_u32 s28, 2
    s_cbranch_scc1 P2_TB
    s_lshl_b32 s31, s29, 8
    s_add_u32 s31, s31, 54525952
    v_and_b32 v3, 31, v0
    v_lshlrev_b32 v3, 2, v3
    s_mov_b32 s50, -1
    s_mov_b32 s51, -1
    s_mov_b32 s47, 0
P2_POLL:
    buffer_load_dword v10, v3, s[20:23], s31 offen sc1
    s_add_u32 s47, s47, 1
    s_waitcnt vmcnt(0)
    v_cmp_eq_u32 s[52:53], 1, v10
    s_cmp_ge_u32 s47, 0x20000
    s_cbranch_scc1 P2_TB
    s_and_b64 s[52:53], s[52:53], s[50:51]
    s_cmp_lg_u64 s[52:53], s[50:51]
    s_cbranch_scc1 P2_POLL
P2_TB:
    s_barrier
    s_add_u32 m0, s48, 0
    s_add_u32 s31, s49, 0
    buffer_load_dwordx4 v1, s[20:23], s31 offen sc1 lds
    s_add_u32 m0, s48, 16384
    s_add_u32 s31, s49, 16384
    buffer_load_dwordx4 v1, s[20:23], s31 offen sc1 lds
    s_add_u32 m0, s48, 8192
    s_add_u32 s31, s49, 8192
    buffer_load_dwordx4 v1, s[20:23], s31 offen sc1 lds
    s_add_u32 m0, s48, 24576
    s_add_u32 s31, s49, 24576
    buffer_load_dwordx4 v1, s[20:23], s31 offen sc1 lds
    s_add_u32 m0, s48, 32768
    s_add_u32 s31, s49, 32768
    buffer_load_dwordx4 v1, s[20:23], s31 offen sc1 lds
    s_waitcnt vmcnt(3)
    s_barrier
    s_waitcnt vmcnt(0)
    s_barrier
    s_endpgm
P2_TP:
    s_sub_u32 s47, s28, 4
    s_lshl_b32 s31, s47, 1
    s_add_u32 s31, s31, s43
    s_lshl_b32 s33, s31, 10
    s_add_u32 s33, s33, 40894464
    buffer_load_dwordx4 v[12:15], v1, s[20:23], s33 offen sc1
    buffer_load_dwordx4 v[16:19], v1, s[20:23], s33 offen offset:1024 sc1
    s_add_u32 s33, s33, 36864
    buffer_load_dwordx4 v[20:23], v1, s[20:23], s33 offen sc1
    buffer_load_dwordx4 v[24:27], v1, s[20:23], s33 offen offset:1024 sc1
    s_add_u32 s33, s33, 36864
    buffer_load_dwordx4 v[28:31], v1, s[20:23], s33 offen sc1
    buffer_load_dwordx4 v[32:35], v1, s[20:23], s33 offen offset:1024 sc1
    s_add_u32 s33, s33, 36864
    buffer_load_dwordx4 v[36:39], v1, s[20:23], s33 offen sc1
    buffer_load_dwordx4 v[40:43], v1, s[20:23], s33 offen offset:1024 sc1
    s_add_u32 s33, s33, 36864
    buffer_load_dwordx4 v[44:47], v1, s[20:23], s33 offen sc1
    buffer_load_dwordx4 v[48:51], v1, s[20:23], s33 offen offset:1024 sc1
    s_add_u32 s33, s33, 36864
    buffer_load_dwordx4 v[52:55], v1, s[20:23], s33 offen sc1
    buffer_load_dwordx4 v[56:59], v1, s[20:23], s33 offen offset:1024 sc1
    s_add_u32 s33, s33, 36864
    buffer_load_dwordx4 v[60:63], v1, s[20:23], s33 offen sc1
    buffer_load_dwordx4 v[64:67], v1, s[20:23], s33 offen offset:1024 sc1
    s_add_u32 s33, s33, 36864
    buffer_load_dwordx4 v[68:71], v1, s[20:23], s33 offen sc1
    buffer_load_dwordx4 v[72:75], v1, s[20:23], s33 offen offset:1024 sc1
    s_add_u32 s33, s33, 36864
    buffer_load_dwordx4 v[76:79], v1, s[20:23], s33 offen sc1
    buffer_load_dwordx4 v[80:83], v1, s[20:23], s33 offen offset:1024 sc1
    s_add_u32 s33, s33, 36864
    buffer_load_dwordx4 v[84:87], v1, s[20:23], s33 offen sc1
    buffer_load_dwordx4 v[88:91], v1, s[20:23], s33 offen offset:1024 sc1
    s_add_u32 s33, s33, 36864
    buffer_load_dwordx4 v[92:95], v1, s[20:23], s33 offen sc1
    buffer_load_dwordx4 v[96:99], v1, s[20:23], s33 offen offset:1024 sc1
    s_add_u32 s33, s33, 36864
    buffer_load_dwordx4 v[100:103], v1, s[20:23], s33 offen sc1
    buffer_load_dwordx4 v[104:107], v1, s[20:23], s33 offen offset:1024 sc1
    s_add_u32 s33, s33, 36864
    buffer_load_dwordx4 v[108:111], v1, s[20:23], s33 offen sc1
    buffer_load_dwordx4 v[112:115], v1, s[20:23], s33 offen offset:1024 sc1
    s_add_u32 s33, s33, 36864
    buffer_load_dwordx4 v[116:119], v1, s[20:23], s33 offen sc1
    buffer_load_dwordx4 v[120:123], v1, s[20:23], s33 offen offset:1024 sc1
    s_add_u32 s33, s33, 36864
    buffer_load_dwordx4 v[124:127], v1, s[20:23], s33 offen sc1
    buffer_load_dwordx4 v[128:131], v1, s[20:23], s33 offen offset:1024 sc1
    s_add_u32 s33, s33, 36864
    buffer_load_dwordx4 v[132:135], v1, s[20:23], s33 offen sc1
    buffer_load_dwordx4 v[136:139], v1, s[20:23], s33 offen offset:1024 sc1
    s_add_u32 s33, s33, 36864
    buffer_load_dwordx4 v[140:143], v1, s[20:23], s33 offen sc1
    buffer_load_dwordx4 v[144:147], v1, s[20:23], s33 offen offset:1024 sc1
    s_add_u32 s33, s33, 36864
    buffer_load_dwordx4 v[148:151], v1, s[20:23], s33 offen sc1
    buffer_load_dwordx4 v[152:155], v1, s[20:23], s33 offen offset:1024 sc1
    s_add_u32 s33, s33, 36864
    s_lshl_b32 s31, s31, 5
    v_add_u32 v2, s31, v2
    buffer_load_dwordx4 v[204:207], v2, s[8:11], 0 offen
    buffer_load_dwordx4 v[208:211], v2, s[8:11], s54 offen
    v_mov_b32 v4, v1
    s_lshl_b32 s31, s47, 10
    s_add_u32 s46, s46, s31
    s_add_u32 s31, s31, 81920
    v_add_u32 v7, s31, v1
    s_lshl_b32 s31, s29, 5
    s_xor_b32 s32, s41, 1
    s_add_u32 s31, s31, s32
    s_lshl_b32 s31, s31, 7
    s_add_u32 s31, s31, 54530048
    v_mov_b32 v3, 0
    s_mov_b32 s47, 0
P2_PP:
    buffer_load_dword v10, v3, s[20:23], s31 offen sc1
    s_add_u32 s47, s47, 1
    s_waitcnt vmcnt(0)
    v_readfirstlane_b32 s32, v10
    s_cmp_ge_u32 s47, 0x20000
    s_cbranch_scc1 P2_PPD
    s_cmp_lg_u32 s32, 1
    s_cbranch_scc1 P2_PP
P2_PPD:
    s_add_u32 s31, s46, 0
    buffer_load_dwordx4 v[172:175], v1, s[20:23], s31 offen sc1
    s_add_u32 s31, s46, 9216
    buffer_load_dwordx4 v[176:179], v1, s[20:23], s31 offen sc1
    s_add_u32 s31, s46, 18432
    buffer_load_dwordx4 v[180:183], v1, s[20:23], s31 offen sc1
    s_add_u32 s31, s46, 27648
    buffer_load_dwordx4 v[184:187], v1, s[20:23], s31 offen sc1
    s_add_u32 s31, s46, 4608
    buffer_load_dwordx4 v[188:191], v1, s[20:23], s31 offen sc1
    s_add_u32 s31, s46, 13824
    buffer_load_dwordx4 v[192:195], v1, s[20:23], s31 offen sc1
    s_add_u32 s31, s46, 23040
    buffer_load_dwordx4 v[196:199], v1, s[20:23], s31 offen sc1
    s_add_u32 s31, s46, 32256
    buffer_load_dwordx4 v[200:203], v1, s[20:23], s31 offen sc1
    s_waitcnt vmcnt(7)
    v_lshlrev_b32 v212, 16, v172
    v_and_b32 v213, v5, v172
    v_lshlrev_b32 v214, 16, v173
    v_and_b32 v215, v5, v173
    v_lshlrev_b32 v216, 16, v174
    v_and_b32 v217, v5, v174
    v_lshlrev_b32 v218, 16, v175
    v_and_b32 v219, v5, v175
    s_waitcnt vmcnt(6)
    v_lshlrev_b32 v10, 16, v176
    v_and_b32 v11, v5, v176
    v_add_f32 v212, v212, v10
    v_add_f32 v213, v213, v11
    v_lshlrev_b32 v10, 16, v177
    v_and_b32 v11, v5, v177
    v_add_f32 v214, v214, v10
    v_add_f32 v215, v215, v11
    v_lshlrev_b32 v10, 16, v178
    v_and_b32 v11, v5, v178
    v_add_f32 v216, v216, v10
    v_add_f32 v217, v217, v11
    v_lshlrev_b32 v10, 16, v179
    v_and_b32 v11, v5, v179
    v_add_f32 v218, v218, v10
    v_add_f32 v219, v219, v11
    s_waitcnt vmcnt(5)
    v_lshlrev_b32 v10, 16, v180
    v_and_b32 v11, v5, v180
    v_add_f32 v212, v212, v10
    v_add_f32 v213, v213, v11
    v_lshlrev_b32 v10, 16, v181
    v_and_b32 v11, v5, v181
    v_add_f32 v214, v214, v10
    v_add_f32 v215, v215, v11
    v_lshlrev_b32 v10, 16, v182
    v_and_b32 v11, v5, v182
    v_add_f32 v216, v216, v10
    v_add_f32 v217, v217, v11
    v_lshlrev_b32 v10, 16, v183
    v_and_b32 v11, v5, v183
    v_add_f32 v218, v218, v10
    v_add_f32 v219, v219, v11
    s_waitcnt vmcnt(4)
    v_lshlrev_b32 v10, 16, v184
    v_and_b32 v11, v5, v184
    v_add_f32 v212, v212, v10
    v_add_f32 v213, v213, v11
    v_lshlrev_b32 v10, 16, v185
    v_and_b32 v11, v5, v185
    v_add_f32 v214, v214, v10
    v_add_f32 v215, v215, v11
    v_lshlrev_b32 v10, 16, v186
    v_and_b32 v11, v5, v186
    v_add_f32 v216, v216, v10
    v_add_f32 v217, v217, v11
    v_lshlrev_b32 v10, 16, v187
    v_and_b32 v11, v5, v187
    v_add_f32 v218, v218, v10
    v_add_f32 v219, v219, v11
    s_waitcnt vmcnt(3)
    v_lshlrev_b32 v220, 16, v188
    v_and_b32 v221, v5, v188
    v_lshlrev_b32 v222, 16, v189
    v_and_b32 v223, v5, v189
    v_lshlrev_b32 v224, 16, v190
    v_and_b32 v225, v5, v190
    v_lshlrev_b32 v226, 16, v191
    v_and_b32 v227, v5, v191
    s_waitcnt vmcnt(2)
    v_lshlrev_b32 v10, 16, v192
    v_and_b32 v11, v5, v192
    v_add_f32 v220, v220, v10
    v_add_f32 v221, v221, v11
    v_lshlrev_b32 v10, 16, v193
    v_and_b32 v11, v5, v193
    v_add_f32 v222, v222, v10
    v_add_f32 v223, v223, v11
    v_lshlrev_b32 v10, 16, v194
    v_and_b32 v11, v5, v194
    v_add_f32 v224, v224, v10
    v_add_f32 v225, v225, v11
    v_lshlrev_b32 v10, 16, v195
    v_and_b32 v11, v5, v195
    v_add_f32 v226, v226, v10
    v_add_f32 v227, v227, v11
    s_waitcnt vmcnt(1)
    v_lshlrev_b32 v10, 16, v196
    v_and_b32 v11, v5, v196
    v_add_f32 v220, v220, v10
    v_add_f32 v221, v221, v11
    v_lshlrev_b32 v10, 16, v197
    v_and_b32 v11, v5, v197
    v_add_f32 v222, v222, v10
    v_add_f32 v223, v223, v11
    v_lshlrev_b32 v10, 16, v198
    v_and_b32 v11, v5, v198
    v_add_f32 v224, v224, v10
    v_add_f32 v225, v225, v11
    v_lshlrev_b32 v10, 16, v199
    v_and_b32 v11, v5, v199
    v_add_f32 v226, v226, v10
    v_add_f32 v227, v227, v11
    s_waitcnt vmcnt(0)
    v_lshlrev_b32 v10, 16, v200
    v_and_b32 v11, v5, v200
    v_add_f32 v220, v220, v10
    v_add_f32 v221, v221, v11
    v_lshlrev_b32 v10, 16, v201
    v_and_b32 v11, v5, v201
    v_add_f32 v222, v222, v10
    v_add_f32 v223, v223, v11
    v_lshlrev_b32 v10, 16, v202
    v_and_b32 v11, v5, v202
    v_add_f32 v224, v224, v10
    v_add_f32 v225, v225, v11
    v_lshlrev_b32 v10, 16, v203
    v_and_b32 v11, v5, v203
    v_add_f32 v226, v226, v10
    v_add_f32 v227, v227, v11
    s_barrier
    ds_read_b128 v[172:175], v7 offset:0
    ds_read_b128 v[176:179], v7 offset:9216
    ds_read_b128 v[180:183], v7 offset:18432
    ds_read_b128 v[184:187], v7 offset:27648
    ds_read_b128 v[188:191], v7 offset:4608
    ds_read_b128 v[192:195], v7 offset:13824
    ds_read_b128 v[196:199], v7 offset:23040
    ds_read_b128 v[200:203], v7 offset:32256
    s_waitcnt lgkmcnt(7)
    v_lshlrev_b32 v10, 16, v172
    v_and_b32 v11, v5, v172
    v_add_f32 v212, v212, v10
    v_add_f32 v213, v213, v11
    v_lshlrev_b32 v10, 16, v173
    v_and_b32 v11, v5, v173
    v_add_f32 v214, v214, v10
    v_add_f32 v215, v215, v11
    v_lshlrev_b32 v10, 16, v174
    v_and_b32 v11, v5, v174
    v_add_f32 v216, v216, v10
    v_add_f32 v217, v217, v11
    v_lshlrev_b32 v10, 16, v175
    v_and_b32 v11, v5, v175
    v_add_f32 v218, v218, v10
    v_add_f32 v219, v219, v11
    s_waitcnt lgkmcnt(6)
    v_lshlrev_b32 v10, 16, v176
    v_and_b32 v11, v5, v176
    v_add_f32 v212, v212, v10
    v_add_f32 v213, v213, v11
    v_lshlrev_b32 v10, 16, v177
    v_and_b32 v11, v5, v177
    v_add_f32 v214, v214, v10
    v_add_f32 v215, v215, v11
    v_lshlrev_b32 v10, 16, v178
    v_and_b32 v11, v5, v178
    v_add_f32 v216, v216, v10
    v_add_f32 v217, v217, v11
    v_lshlrev_b32 v10, 16, v179
    v_and_b32 v11, v5, v179
    v_add_f32 v218, v218, v10
    v_add_f32 v219, v219, v11
    s_waitcnt lgkmcnt(5)
    v_lshlrev_b32 v10, 16, v180
    v_and_b32 v11, v5, v180
    v_add_f32 v212, v212, v10
    v_add_f32 v213, v213, v11
    v_lshlrev_b32 v10, 16, v181
    v_and_b32 v11, v5, v181
    v_add_f32 v214, v214, v10
    v_add_f32 v215, v215, v11
    v_lshlrev_b32 v10, 16, v182
    v_and_b32 v11, v5, v182
    v_add_f32 v216, v216, v10
    v_add_f32 v217, v217, v11
    v_lshlrev_b32 v10, 16, v183
    v_and_b32 v11, v5, v183
    v_add_f32 v218, v218, v10
    v_add_f32 v219, v219, v11
    s_waitcnt lgkmcnt(4)
    v_lshlrev_b32 v10, 16, v184
    v_and_b32 v11, v5, v184
    v_add_f32 v212, v212, v10
    v_add_f32 v213, v213, v11
    v_lshlrev_b32 v10, 16, v185
    v_and_b32 v11, v5, v185
    v_add_f32 v214, v214, v10
    v_add_f32 v215, v215, v11
    v_lshlrev_b32 v10, 16, v186
    v_and_b32 v11, v5, v186
    v_add_f32 v216, v216, v10
    v_add_f32 v217, v217, v11
    v_lshlrev_b32 v10, 16, v187
    v_and_b32 v11, v5, v187
    v_add_f32 v218, v218, v10
    v_add_f32 v219, v219, v11
    s_waitcnt lgkmcnt(3)
    v_lshlrev_b32 v10, 16, v188
    v_and_b32 v11, v5, v188
    v_add_f32 v220, v220, v10
    v_add_f32 v221, v221, v11
    v_lshlrev_b32 v10, 16, v189
    v_and_b32 v11, v5, v189
    v_add_f32 v222, v222, v10
    v_add_f32 v223, v223, v11
    v_lshlrev_b32 v10, 16, v190
    v_and_b32 v11, v5, v190
    v_add_f32 v224, v224, v10
    v_add_f32 v225, v225, v11
    v_lshlrev_b32 v10, 16, v191
    v_and_b32 v11, v5, v191
    v_add_f32 v226, v226, v10
    v_add_f32 v227, v227, v11
    s_waitcnt lgkmcnt(2)
    v_lshlrev_b32 v10, 16, v192
    v_and_b32 v11, v5, v192
    v_add_f32 v220, v220, v10
    v_add_f32 v221, v221, v11
    v_lshlrev_b32 v10, 16, v193
    v_and_b32 v11, v5, v193
    v_add_f32 v222, v222, v10
    v_add_f32 v223, v223, v11
    v_lshlrev_b32 v10, 16, v194
    v_and_b32 v11, v5, v194
    v_add_f32 v224, v224, v10
    v_add_f32 v225, v225, v11
    v_lshlrev_b32 v10, 16, v195
    v_and_b32 v11, v5, v195
    v_add_f32 v226, v226, v10
    v_add_f32 v227, v227, v11
    s_waitcnt lgkmcnt(1)
    v_lshlrev_b32 v10, 16, v196
    v_and_b32 v11, v5, v196
    v_add_f32 v220, v220, v10
    v_add_f32 v221, v221, v11
    v_lshlrev_b32 v10, 16, v197
    v_and_b32 v11, v5, v197
    v_add_f32 v222, v222, v10
    v_add_f32 v223, v223, v11
    v_lshlrev_b32 v10, 16, v198
    v_and_b32 v11, v5, v198
    v_add_f32 v224, v224, v10
    v_add_f32 v225, v225, v11
    v_lshlrev_b32 v10, 16, v199
    v_and_b32 v11, v5, v199
    v_add_f32 v226, v226, v10
    v_add_f32 v227, v227, v11
    s_waitcnt lgkmcnt(0)
    v_lshlrev_b32 v10, 16, v200
    v_and_b32 v11, v5, v200
    v_add_f32 v220, v220, v10
    v_add_f32 v221, v221, v11
    v_lshlrev_b32 v10, 16, v201
    v_and_b32 v11, v5, v201
    v_add_f32 v222, v222, v10
    v_add_f32 v223, v223, v11
    v_lshlrev_b32 v10, 16, v202
    v_and_b32 v11, v5, v202
    v_add_f32 v224, v224, v10
    v_add_f32 v225, v225, v11
    v_lshlrev_b32 v10, 16, v203
    v_and_b32 v11, v5, v203
    v_add_f32 v226, v226, v10
    v_add_f32 v227, v227, v11
    s_barrier
    s_add_u32 m0, s48, 0
    s_add_u32 s31, s49, 0
    buffer_load_dwordx4 v1, s[20:23], s31 offen sc1 lds
    s_add_u32 m0, s48, 16384
    s_add_u32 s31, s49, 16384
    buffer_load_dwordx4 v1, s[20:23], s31 offen sc1 lds
    s_add_u32 m0, s48, 8192
    s_add_u32 s31, s49, 8192
    buffer_load_dwordx4 v1, s[20:23], s31 offen sc1 lds
    s_add_u32 m0, s48, 24576
    s_add_u32 s31, s49, 24576
    buffer_load_dwordx4 v1, s[20:23], s31 offen sc1 lds
    v_mul_f32 v228, 0xbfb8aa3b, v212
    v_mul_f32 v229, 0xbfb8aa3b, v213
    v_mul_f32 v230, 0xbfb8aa3b, v214
    v_mul_f32 v231, 0xbfb8aa3b, v215
    v_mul_f32 v232, 0xbfb8aa3b, v216
    v_mul_f32 v233, 0xbfb8aa3b, v217
    v_mul_f32 v234, 0xbfb8aa3b, v218
    v_mul_f32 v235, 0xbfb8aa3b, v219
    v_mul_f32 v236, 0xbfb8aa3b, v220
    v_mul_f32 v237, 0xbfb8aa3b, v221
    v_mul_f32 v238, 0xbfb8aa3b, v222
    v_mul_f32 v239, 0xbfb8aa3b, v223
    v_mul_f32 v240, 0xbfb8aa3b, v224
    v_mul_f32 v241, 0xbfb8aa3b, v225
    v_mul_f32 v242, 0xbfb8aa3b, v226
    v_mul_f32 v243, 0xbfb8aa3b, v227
    v_exp_f32 v228, v228
    v_exp_f32 v229, v229
    v_exp_f32 v230, v230
    v_exp_f32 v231, v231
    v_exp_f32 v232, v232
    v_exp_f32 v233, v233
    v_exp_f32 v234, v234
    v_exp_f32 v235, v235
    v_exp_f32 v236, v236
    v_exp_f32 v237, v237
    v_exp_f32 v238, v238
    v_exp_f32 v239, v239
    v_exp_f32 v240, v240
    v_exp_f32 v241, v241
    v_exp_f32 v242, v242
    v_exp_f32 v243, v243
    v_add_f32 v228, 1.0, v228
    v_add_f32 v229, 1.0, v229
    v_add_f32 v230, 1.0, v230
    v_add_f32 v231, 1.0, v231
    v_add_f32 v232, 1.0, v232
    v_add_f32 v233, 1.0, v233
    v_add_f32 v234, 1.0, v234
    v_add_f32 v235, 1.0, v235
    v_add_f32 v236, 1.0, v236
    v_add_f32 v237, 1.0, v237
    v_add_f32 v238, 1.0, v238
    v_add_f32 v239, 1.0, v239
    v_add_f32 v240, 1.0, v240
    v_add_f32 v241, 1.0, v241
    v_add_f32 v242, 1.0, v242
    v_add_f32 v243, 1.0, v243
    v_rcp_f32 v228, v228
    v_rcp_f32 v229, v229
    v_rcp_f32 v230, v230
    v_rcp_f32 v231, v231
    v_rcp_f32 v232, v232
    v_rcp_f32 v233, v233
    v_rcp_f32 v234, v234
    v_rcp_f32 v235, v235
    v_rcp_f32 v236, v236
    v_rcp_f32 v237, v237
    v_rcp_f32 v238, v238
    v_rcp_f32 v239, v239
    v_rcp_f32 v240, v240
    v_rcp_f32 v241, v241
    v_rcp_f32 v242, v242
    v_rcp_f32 v243, v243
    v_mul_f32 v228, v228, v212
    v_mul_f32 v229, v229, v213
    v_mul_f32 v230, v230, v214
    v_mul_f32 v231, v231, v215
    v_mul_f32 v232, v232, v216
    v_mul_f32 v233, v233, v217
    v_mul_f32 v234, v234, v218
    v_mul_f32 v235, v235, v219
    v_mul_f32 v236, v236, v220
    v_mul_f32 v237, v237, v221
    v_mul_f32 v238, v238, v222
    v_mul_f32 v239, v239, v223
    v_mul_f32 v240, v240, v224
    v_mul_f32 v241, v241, v225
    v_mul_f32 v242, v242, v226
    v_mul_f32 v243, v243, v227
    v_lshlrev_b32 v212, 16, v204
    v_and_b32 v213, v5, v204
    v_lshlrev_b32 v214, 16, v205
    v_and_b32 v215, v5, v205
    v_lshlrev_b32 v216, 16, v206
    v_and_b32 v217, v5, v206
    v_lshlrev_b32 v218, 16, v207
    v_and_b32 v219, v5, v207
    v_lshlrev_b32 v220, 16, v208
    v_and_b32 v221, v5, v208
    v_lshlrev_b32 v222, 16, v209
    v_and_b32 v223, v5, v209
    v_lshlrev_b32 v224, 16, v210
    v_and_b32 v225, v5, v210
    v_lshlrev_b32 v226, 16, v211
    v_and_b32 v227, v5, v211
    s_waitcnt vmcnt(2)
    s_barrier
    ds_read_b128 v[172:175], v4 offset:0
    ds_read_b128 v[176:179], v4 offset:16384
    ds_read_b128 v[180:183], v4 offset:1024
    ds_read_b128 v[184:187], v4 offset:17408
    ds_read_b128 v[188:191], v4 offset:2048
    ds_read_b128 v[192:195], v4 offset:18432
    s_waitcnt lgkmcnt(5)
    v_mfma_f32_16x16x32_bf16 v[156:159], v[12:15], v[172:175], 0
    ds_read_b128 v[196:199], v4 offset:3072
    ds_read_b128 v[200:203], v4 offset:19456
    v_mfma_f32_16x16x32_bf16 v[160:163], v[16:19], v[172:175], 0
    s_waitcnt lgkmcnt(6)
    v_mfma_f32_16x16x32_bf16 v[164:167], v[12:15], v[176:179], 0
    v_mfma_f32_16x16x32_bf16 v[168:171], v[16:19], v[176:179], 0
    s_waitcnt lgkmcnt(5)
    v_mfma_f32_16x16x32_bf16 v[156:159], v[20:23], v[180:183], v[156:159]
    ds_read_b128 v[172:175], v4 offset:4096
    ds_read_b128 v[176:179], v4 offset:20480
    v_mfma_f32_16x16x32_bf16 v[160:163], v[24:27], v[180:183], v[160:163]
    s_waitcnt lgkmcnt(6)
    v_mfma_f32_16x16x32_bf16 v[164:167], v[20:23], v[184:187], v[164:167]
    v_mfma_f32_16x16x32_bf16 v[168:171], v[24:27], v[184:187], v[168:171]
    s_waitcnt lgkmcnt(5)
    v_mfma_f32_16x16x32_bf16 v[156:159], v[28:31], v[188:191], v[156:159]
    ds_read_b128 v[180:183], v4 offset:5120
    ds_read_b128 v[184:187], v4 offset:21504
    v_mfma_f32_16x16x32_bf16 v[160:163], v[32:35], v[188:191], v[160:163]
    s_waitcnt lgkmcnt(6)
    v_mfma_f32_16x16x32_bf16 v[164:167], v[28:31], v[192:195], v[164:167]
    v_mfma_f32_16x16x32_bf16 v[168:171], v[32:35], v[192:195], v[168:171]
    s_waitcnt lgkmcnt(5)
    v_mfma_f32_16x16x32_bf16 v[156:159], v[36:39], v[196:199], v[156:159]
    ds_read_b128 v[188:191], v4 offset:6144
    ds_read_b128 v[192:195], v4 offset:22528
    v_mfma_f32_16x16x32_bf16 v[160:163], v[40:43], v[196:199], v[160:163]
    s_waitcnt lgkmcnt(6)
    v_mfma_f32_16x16x32_bf16 v[164:167], v[36:39], v[200:203], v[164:167]
    v_mfma_f32_16x16x32_bf16 v[168:171], v[40:43], v[200:203], v[168:171]
    s_waitcnt lgkmcnt(5)
    v_mfma_f32_16x16x32_bf16 v[156:159], v[44:47], v[172:175], v[156:159]
    ds_read_b128 v[196:199], v4 offset:7168
    ds_read_b128 v[200:203], v4 offset:23552
    v_mfma_f32_16x16x32_bf16 v[160:163], v[48:51], v[172:175], v[160:163]
    s_waitcnt lgkmcnt(6)
    v_mfma_f32_16x16x32_bf16 v[164:167], v[44:47], v[176:179], v[164:167]
    v_mfma_f32_16x16x32_bf16 v[168:171], v[48:51], v[176:179], v[168:171]
    s_waitcnt lgkmcnt(5)
    v_mfma_f32_16x16x32_bf16 v[156:159], v[52:55], v[180:183], v[156:159]
    s_waitcnt vmcnt(0)
    s_barrier
    ds_read_b128 v[172:175], v4 offset:8192
    ds_read_b128 v[176:179], v4 offset:24576
    v_mfma_f32_16x16x32_bf16 v[160:163], v[56:59], v[180:183], v[160:163]
    s_waitcnt lgkmcnt(6)
    v_mfma_f32_16x16x32_bf16 v[164:167], v[52:55], v[184:187], v[164:167]
    v_mfma_f32_16x16x32_bf16 v[168:171], v[56:59], v[184:187], v[168:171]
    s_waitcnt lgkmcnt(5)
    v_mfma_f32_16x16x32_bf16 v[156:159], v[60:63], v[188:191], v[156:159]
    ds_read_b128 v[180:183], v4 offset:9216
    ds_read_b128 v[184:187], v4 offset:25600
    v_mfma_f32_16x16x32_bf16 v[160:163], v[64:67], v[188:191], v[160:163]
    s_waitcnt lgkmcnt(6)
    v_mfma_f32_16x16x32_bf16 v[164:167], v[60:63], v[192:195], v[164:167]
    v_mfma_f32_16x16x32_bf16 v[168:171], v[64:67], v[192:195], v[168:171]
    s_waitcnt lgkmcnt(5)
    v_mfma_f32_16x16x32_bf16 v[156:159], v[68:71], v[196:199], v[156:159]
    ds_read_b128 v[188:191], v4 offset:10240
    ds_read_b128 v[192:195], v4 offset:26624
    v_mfma_f32_16x16x32_bf16 v[160:163], v[72:75], v[196:199], v[160:163]
    s_waitcnt lgkmcnt(6)
    v_mfma_f32_16x16x32_bf16 v[164:167], v[68:71], v[200:203], v[164:167]
    v_mfma_f32_16x16x32_bf16 v[168:171], v[72:75], v[200:203], v[168:171]
    s_waitcnt lgkmcnt(5)
    v_mfma_f32_16x16x32_bf16 v[156:159], v[76:79], v[172:175], v[156:159]
    ds_read_b128 v[196:199], v4 offset:11264
    ds_read_b128 v[200:203], v4 offset:27648
    v_mfma_f32_16x16x32_bf16 v[160:163], v[80:83], v[172:175], v[160:163]
    s_waitcnt lgkmcnt(6)
    v_mfma_f32_16x16x32_bf16 v[164:167], v[76:79], v[176:179], v[164:167]
    v_mfma_f32_16x16x32_bf16 v[168:171], v[80:83], v[176:179], v[168:171]
    s_waitcnt lgkmcnt(5)
    v_mfma_f32_16x16x32_bf16 v[156:159], v[84:87], v[180:183], v[156:159]
    ds_read_b128 v[172:175], v4 offset:12288
    ds_read_b128 v[176:179], v4 offset:28672
    v_mfma_f32_16x16x32_bf16 v[160:163], v[88:91], v[180:183], v[160:163]
    s_waitcnt lgkmcnt(6)
    v_mfma_f32_16x16x32_bf16 v[164:167], v[84:87], v[184:187], v[164:167]
    v_mfma_f32_16x16x32_bf16 v[168:171], v[88:91], v[184:187], v[168:171]
    s_waitcnt lgkmcnt(5)
    v_mfma_f32_16x16x32_bf16 v[156:159], v[92:95], v[188:191], v[156:159]
    ds_read_b128 v[180:183], v4 offset:13312
    ds_read_b128 v[184:187], v4 offset:29696
    v_mfma_f32_16x16x32_bf16 v[160:163], v[96:99], v[188:191], v[160:163]
    s_waitcnt lgkmcnt(6)
    v_mfma_f32_16x16x32_bf16 v[164:167], v[92:95], v[192:195], v[164:167]
    v_mfma_f32_16x16x32_bf16 v[168:171], v[96:99], v[192:195], v[168:171]
    s_waitcnt lgkmcnt(5)
    v_mfma_f32_16x16x32_bf16 v[156:159], v[100:103], v[196:199], v[156:159]
    ds_read_b128 v[188:191], v4 offset:14336
    ds_read_b128 v[192:195], v4 offset:30720
    v_mfma_f32_16x16x32_bf16 v[160:163], v[104:107], v[196:199], v[160:163]
    s_waitcnt lgkmcnt(6)
    v_mfma_f32_16x16x32_bf16 v[164:167], v[100:103], v[200:203], v[164:167]
    v_mfma_f32_16x16x32_bf16 v[168:171], v[104:107], v[200:203], v[168:171]
    s_waitcnt lgkmcnt(5)
    v_mfma_f32_16x16x32_bf16 v[156:159], v[108:111], v[172:175], v[156:159]
    ds_read_b128 v[196:199], v4 offset:15360
    ds_read_b128 v[200:203], v4 offset:31744
    v_mfma_f32_16x16x32_bf16 v[160:163], v[112:115], v[172:175], v[160:163]
    s_waitcnt lgkmcnt(6)
    v_mfma_f32_16x16x32_bf16 v[164:167], v[108:111], v[176:179], v[164:167]
    v_mfma_f32_16x16x32_bf16 v[168:171], v[112:115], v[176:179], v[168:171]
    s_waitcnt lgkmcnt(5)
    v_mfma_f32_16x16x32_bf16 v[156:159], v[116:119], v[180:183], v[156:159]
    ds_read_b32 v172, v6 offset:0
    ds_read_b32 v173, v6 offset:128
    ds_read_b32 v174, v6 offset:256
    ds_read_b32 v175, v6 offset:384
    ds_read_b32 v176, v6 offset:64
    ds_read_b32 v177, v6 offset:192
    ds_read_b32 v178, v6 offset:320
    ds_read_b32 v179, v6 offset:448
    v_mfma_f32_16x16x32_bf16 v[160:163], v[120:123], v[180:183], v[160:163]
    s_waitcnt lgkmcnt(12)
    v_mfma_f32_16x16x32_bf16 v[164:167], v[116:119], v[184:187], v[164:167]
    v_mfma_f32_16x16x32_bf16 v[168:171], v[120:123], v[184:187], v[168:171]
    s_waitcnt lgkmcnt(11)
    v_mfma_f32_16x16x32_bf16 v[156:159], v[124:127], v[188:191], v[156:159]
    ds_read_b32 v180, v6 offset:2048
    ds_read_b32 v181, v6 offset:2176
    ds_read_b32 v182, v6 offset:2304
    ds_read_b32 v183, v6 offset:2432
    ds_read_b32 v184, v6 offset:2112
    ds_read_b32 v185, v6 offset:2240
    ds_read_b32 v186, v6 offset:2368
    ds_read_b32 v187, v6 offset:2496
    v_mfma_f32_16x16x32_bf16 v[160:163], v[128:131], v[188:191], v[160:163]
    s_waitcnt lgkmcnt(15)
    v_mfma_f32_16x16x32_bf16 v[164:167], v[124:127], v[192:195], v[164:167]
    v_mfma_f32_16x16x32_bf16 v[168:171], v[128:131], v[192:195], v[168:171]
    v_mfma_f32_16x16x32_bf16 v[156:159], v[132:135], v[196:199], v[156:159]
    v_mfma_f32_16x16x32_bf16 v[160:163], v[136:139], v[196:199], v[160:163]
    v_mfma_f32_16x16x32_bf16 v[164:167], v[132:135], v[200:203], v[164:167]
    v_mfma_f32_16x16x32_bf16 v[168:171], v[136:139], v[200:203], v[168:171]
    s_waitcnt lgkmcnt(12)
    v_mfma_f32_16x16x32_bf16 v[156:159], v[140:143], v[172:175], v[156:159]
    v_mfma_f32_16x16x32_bf16 v[160:163], v[144:147], v[172:175], v[160:163]
    s_waitcnt lgkmcnt(8)
    v_mfma_f32_16x16x32_bf16 v[164:167], v[140:143], v[176:179], v[164:167]
    v_mfma_f32_16x16x32_bf16 v[168:171], v[144:147], v[176:179], v[168:171]
    s_waitcnt lgkmcnt(4)
    v_mfma_f32_16x16x32_bf16 v[156:159], v[148:151], v[180:183], v[156:159]
    v_mfma_f32_16x16x32_bf16 v[160:163], v[152:155], v[180:183], v[160:163]
    s_waitcnt lgkmcnt(0)
    v_mfma_f32_16x16x32_bf16 v[164:167], v[148:151], v[184:187], v[164:167]
    v_mfma_f32_16x16x32_bf16 v[168:171], v[152:155], v[184:187], v[168:171]
    s_nop 3
    v_fmac_f32 v212, v156, v228
    v_fmac_f32 v213, v157, v229
    v_fmac_f32 v214, v158, v230
    v_fmac_f32 v215, v159, v231
    v_fmac_f32 v216, v160, v232
    v_fmac_f32 v217, v161, v233
    v_fmac_f32 v218, v162, v234
    v_fmac_f32 v219, v163, v235
    v_fmac_f32 v220, v164, v236
    v_fmac_f32 v221, v165, v237
    v_fmac_f32 v222, v166, v238
    v_fmac_f32 v223, v167, v239
    v_fmac_f32 v224, v168, v240
    v_fmac_f32 v225, v169, v241
    v_fmac_f32 v226, v170, v242
    v_fmac_f32 v227, v171, v243
    v_cvt_pk_bf16_f32 v204, v212, v213
    v_cvt_pk_bf16_f32 v205, v214, v215
    v_cvt_pk_bf16_f32 v206, v216, v217
    v_cvt_pk_bf16_f32 v207, v218, v219
    v_cvt_pk_bf16_f32 v208, v220, v221
    v_cvt_pk_bf16_f32 v209, v222, v223
    v_cvt_pk_bf16_f32 v210, v224, v225
    v_cvt_pk_bf16_f32 v211, v226, v227
    buffer_store_dwordx4 v[204:207], v2, s[12:15], 0 offen
    buffer_store_dwordx4 v[208:211], v2, s[12:15], s54 offen
K1_END:
    s_endpgm
.section .rodata,"a"
.p2align 6
.amdhsa_kernel recurrent_scan__softmax_full_mha__geglu_ffn__prompt_kernel
  .amdhsa_next_free_vgpr 256
  .amdhsa_next_free_sgpr 102
  .amdhsa_accum_offset 256
  .amdhsa_group_segment_fixed_size 0
  .amdhsa_kernarg_size 80
  .amdhsa_user_sgpr_count 2
  .amdhsa_user_sgpr_kernarg_segment_ptr 1
  .amdhsa_system_sgpr_workgroup_id_x 1
.end_amdhsa_kernel
```
